```python
import torch

def _softmax(x, axis=-1):
    return torch.softmax(x, dim=axis)
def _gelu(x):
    return torch.nn.functional.gelu(x, approximate="tanh")
def _silu(x):
    return torch.nn.functional.silu(x)
def _sigmoid(x):
    return torch.sigmoid(x)
def _layernorm(x, axis=-1, eps=1e-5):
    m = x.mean(dim=axis, keepdim=True)
    v = x.var(dim=axis, keepdim=True, unbiased=False)
    return (x - m) / torch.sqrt(v + eps)
def _scatter_add(tgt, idx, src, axis=0):
    return tgt.clone().index_add_(axis, idx, src)
def _segment_sum(src, seg, n):
    out = torch.zeros((n,) + src.shape[1:], dtype=src.dtype)
    return out.index_add_(0, seg, src)
def _pad(x, pw):
    flat = tuple(v for pair in reversed(pw) for v in pair)
    return torch.nn.functional.pad(x, flat)

kernel_name = 'sequential_preLN__gqa_block_cached__geglu_ffn__decode'

def setup_inputs():

    _w = (lambda a: (lambda t: t.to(torch.bfloat16) if t.is_floating_point() else t)(torch.as_tensor(a)))
    def _A_setup():
        B, Sq, D = 1, 1, 512
        Hq, Hkv, Sk, Dh = 32, 8, 65536, 128
        assert Hq % Hkv == 0, (Hq, Hkv)
        return {
            "x": _w((lambda *s: torch.randn(*s, dtype=torch.bfloat16) * 0.05)(B, Sq, D)),
            "k_cache": _w((lambda *s: torch.randn(*s, dtype=torch.bfloat16) * 3.2)(B, Hkv, Sk, Dh)),
            "v_cache": _w((lambda *s: torch.randn(*s, dtype=torch.bfloat16) * 0.4)(B, Hkv, Sk, Dh)),
            "wq": _w((lambda *s: torch.randn(*s, dtype=torch.bfloat16) * 3.2)(D, Hq * Dh) * (D ** -0.5)),
            "wo": _w((lambda *s: torch.randn(*s, dtype=torch.bfloat16) * 0.4)(Hq * Dh, D) * ((Hq * Dh) ** -0.5)),
        }
    _A_in = _A_setup()

    def _B_setup():
        B, S, D, F = 1, 1, 512, 1792
        return {
            "x": _w((lambda *s: torch.randn(*s, dtype=torch.bfloat16) * 0.05)(B, S, D)),
            "w_gate": _w((lambda *s: torch.randn(*s, dtype=torch.bfloat16) * 0.05)(D, F)),
            "w_up": _w((lambda *s: torch.randn(*s, dtype=torch.bfloat16) * 0.05)(D, F)),
            "w_down": _w((lambda *s: torch.randn(*s, dtype=torch.bfloat16) * 0.05)(F, D)),
        }
    _B_in = _B_setup()

    return {
        "A_x": _A_in["x"],
        "A_k_cache": _A_in["k_cache"],
        "A_v_cache": _A_in["v_cache"],
        "A_wq": _A_in["wq"],
        "A_wo": _A_in["wo"],
        "B_x": _B_in["x"],
        "B_w_gate": _B_in["w_gate"],
        "B_w_up": _B_in["w_up"],
        "B_w_down": _B_in["w_down"],
    }

def reference(A_x, A_k_cache, A_v_cache, A_wq, A_wo, B_x, B_w_gate, B_w_up, B_w_down):
    def _A_ref(x, k_cache, v_cache, wq, wo):
        B, Sq, D = x.shape
        Hq, Dh = 32, 128
        Hkv = k_cache.shape[1]
        rep = Hq // Hkv
        q = (lambda x, *d: x.permute(*d))((x @ wq).reshape(B, Sq, Hq, Dh), 0, 2, 1, 3)
        k = (lambda x, n, axis: torch.repeat_interleave(x, n, dim=axis))(k_cache, rep, axis=1)
        v = (lambda x, n, axis: torch.repeat_interleave(x, n, dim=axis))(v_cache, rep, axis=1)
        scores = torch.einsum("bhqd,bhkd->bhqk", q, k) * (Dh ** -0.5)
        p = _softmax(scores, axis=-1)
        o = torch.einsum("bhqk,bhkd->bhqd", p, v)
        return (lambda x, *d: x.permute(*d))(o, 0, 2, 1, 3).reshape(B, Sq, Hq * Dh) @ wo

    def _B_ref(x, w_gate, w_up, w_down):
        return (_gelu(x @ w_gate) * (x @ w_up)) @ w_down

    x = A_x
    h = x + _A_ref(_layernorm(x, axis=-1), A_k_cache, A_v_cache, A_wq, A_wo)
    h2 = h + _B_ref(_layernorm(h, axis=-1), B_w_gate, B_w_up, B_w_down)
    return h2
```

```asm
; @launch grid=(256,1,1) block=(576,1,1) lds=134144
.amdgcn_target "amdgcn-amd-amdhsa--gfx950"
.text
.globl sequential_preLN__gqa_block_cached__geglu_ffn__decode_kernel
.p2align 12
.fill 448, 4, 0xbf810000
.p2align 8
.type sequential_preLN__gqa_block_cached__geglu_ffn__decode_kernel,@function
sequential_preLN__gqa_block_cached__geglu_ffn__decode_kernel:
  s_cmp_ge_u32 s2, 256
  s_cbranch_scc1 K_exit
  s_load_dwordx16 s[56:71], s[0:1], 0
  s_load_dwordx8 s[72:79], s[0:1], 64
  v_lshrrev_b32 v1, 6, v0
  s_nop 0
  v_readfirstlane_b32 s3, v1
  v_and_b32 v2, 63, v0
  s_lshr_b32 s81, s2, 3
  s_add_u32 s80, s2, s81
  s_and_b32 s80, s80, 7
  s_and_b32 s86, s2, 7
  s_cmp_ge_u32 s81, 24
  s_cselect_b32 s80, s86, s80
  s_cmp_eq_u32 s3, 8
  s_cbranch_scc1 K_helper
  s_cmp_ge_u32 s81, 24
  s_cbranch_scc1 L_svc
  v_lshrrev_b32 v3, 4, v2
  v_and_b32 v4, 15, v2
  v_xor_b32 v5, v4, v3
  v_lshlrev_b32 v5, 4, v5
  v_lshl_add_u32 v10, v3, 8, v5
  v_xor_b32 v11, 64, v10
  v_xor_b32 v12, 128, v10
  v_xor_b32 v13, 192, v10
  v_lshlrev_b32 v5, 1, v3
  v_xor_b32 v5, v4, v5
  v_lshlrev_b32 v5, 4, v5
  v_lshl_add_u32 v14, v3, 8, v5
  v_xor_b32 v15, 0x80, v14
  s_lshl_b32 s86, s3, 14
  s_add_u32 s42, s86, 0
  s_add_u32 s43, s86, 4096
  s_add_u32 s44, s86, 8192
  s_add_u32 s45, s86, 12288
  s_cmp_lt_u32 s3, 4
  s_cselect_b32 s86, 22, 18
  s_cselect_b32 s87, 0, 8634368
  s_mul_i32 s86, s86, s81
  s_lshl_b32 s86, s86, 14
  s_add_u32 s86, s86, s87
  s_lshl_b32 s87, s3, 12
  s_add_u32 s86, s86, s87
  s_lshl_b32 s87, s80, 24
  s_add_u32 s40, s86, s87
  s_mov_b32 s41, s40
  s_lshr_b32 s86, s81, 3
  s_mul_i32 s86, s86, 192
  s_mul_i32 s87, s3, 24
  s_add_u32 s86, s86, s87
  v_lshrrev_b32 v4, 3, v2
  v_add_u32 v4, s86, v4
  s_lshl_b32 s87, s80, 10
  s_and_b32 s88, s81, 7
  s_lshl_b32 s88, s88, 7
  s_add_u32 s87, s87, s88
  v_and_b32 v3, 7, v2
  v_lshlrev_b32 v5, 13, v4
  v_lshl_add_u32 v5, v3, 4, v5
  v_add_u32 v5, s87, v5
  v_lshlrev_b32 v6, 4, v2
  v_lshlrev_b32 v7, 1, v4
  s_mov_b32 s87, 0x10000
  s_mov_b32 s88, 0x20000
  s_waitcnt lgkmcnt(0)
  s_mov_b32 s16, s56
  s_and_b32 s17, s57, 0xffff
  s_mov_b32 s18, 0x400
  s_mov_b32 s19, 0x20000
  s_mov_b32 s20, s62
  s_and_b32 s21, s63, 0xffff
  s_mov_b32 s22, 0x400000
  s_mov_b32 s23, 0x20000
  buffer_load_dwordx4 v[44:47], v6, s[16:19], 0 offen
  buffer_load_ushort v48, v7, s[16:19], 0 offen offset:0
  buffer_load_ushort v49, v7, s[16:19], 0 offen offset:16
  buffer_load_ushort v50, v7, s[16:19], 0 offen offset:32
  buffer_load_dwordx4 v[52:55], v5, s[20:23], 0 offen nt
  buffer_load_dwordx4 v[56:59], v5, s[20:23], s87 offen nt
  buffer_load_dwordx4 v[60:63], v5, s[20:23], s88 offen nt
  s_mov_b32 s4, s58
  s_and_b32 s5, s59, 0xffff
  s_mov_b32 s6, 0x8000000
  s_mov_b32 s7, 0x20000
  s_mov_b32 s8, s60
  s_and_b32 s9, s61, 0xffff
  s_mov_b32 s10, 0x8000000
  s_mov_b32 s11, 0x20000
  s_mov_b32 s12, s78
  s_and_b32 s13, s79, 0xffff
  s_mov_b32 s14, 0x400000
  s_mov_b32 s15, 0x20000
  s_barrier
  s_mov_b32 m0, s42
  s_nop 0
  buffer_load_dwordx4 v10, s[4:7], s40 offen offset:0 nt lds
  buffer_load_dwordx4 v11, s[4:7], s40 offen offset:1024 nt lds
  buffer_load_dwordx4 v12, s[4:7], s40 offen offset:2048 nt lds
  buffer_load_dwordx4 v13, s[4:7], s40 offen offset:3072 nt lds
  s_add_u32 s40, s40, 0x4000
  s_mov_b32 s28, s68
  s_and_b32 s29, s69, 0xffff
  s_mov_b32 s30, 0x1c0000
  s_mov_b32 s31, 0x20000
  s_mov_b32 s32, s70
  s_and_b32 s33, s71, 0xffff
  s_mov_b32 s34, 0x1c0000
  s_mov_b32 s35, 0x20000
  s_mov_b32 s36, s72
  s_and_b32 s37, s73, 0xffff
  s_mov_b32 s38, 0x1c0000
  s_mov_b32 s39, 0x20000
  s_waitcnt vmcnt(10)
  v_lshlrev_b32 v64, 16, v44
  v_and_b32 v65, 0xffff0000, v44
  v_lshlrev_b32 v66, 16, v45
  v_and_b32 v67, 0xffff0000, v45
  v_lshlrev_b32 v68, 16, v46
  v_and_b32 v69, 0xffff0000, v46
  v_lshlrev_b32 v70, 16, v47
  v_and_b32 v71, 0xffff0000, v47
  v_add_f32 v76, v64, v65
  v_add_f32 v76, v76, v66
  v_add_f32 v76, v76, v67
  v_add_f32 v76, v76, v68
  v_add_f32 v76, v76, v69
  v_add_f32 v76, v76, v70
  v_add_f32 v76, v76, v71
  s_nop 1
  v_add_f32_dpp v76, v76, v76 quad_perm:[1,0,3,2] row_mask:0xf bank_mask:0xf
  s_nop 1
  v_add_f32_dpp v76, v76, v76 quad_perm:[2,3,0,1] row_mask:0xf bank_mask:0xf
  s_nop 1
  v_add_f32_dpp v76, v76, v76 row_ror:4 row_mask:0xf bank_mask:0xf
  s_nop 1
  v_add_f32_dpp v76, v76, v76 row_ror:8 row_mask:0xf bank_mask:0xf
  v_mov_b32 v77, v76
  s_nop 1
  v_permlane16_swap_b32 v76, v77
  v_add_f32 v76, v76, v77
  v_mov_b32 v77, v76
  s_nop 1
  v_permlane32_swap_b32 v76, v77
  v_add_f32 v76, v76, v77
  v_mul_f32 v76, 0x3b000000, v76
  v_sub_f32 v78, v64, v76
  v_mul_f32 v77, v78, v78
  v_sub_f32 v78, v65, v76
  v_fmac_f32 v77, v78, v78
  v_sub_f32 v78, v66, v76
  v_fmac_f32 v77, v78, v78
  v_sub_f32 v78, v67, v76
  v_fmac_f32 v77, v78, v78
  v_sub_f32 v78, v68, v76
  v_fmac_f32 v77, v78, v78
  v_sub_f32 v78, v69, v76
  v_fmac_f32 v77, v78, v78
  v_sub_f32 v78, v70, v76
  v_fmac_f32 v77, v78, v78
  v_sub_f32 v78, v71, v76
  v_fmac_f32 v77, v78, v78
  s_nop 1
  v_add_f32_dpp v77, v77, v77 quad_perm:[1,0,3,2] row_mask:0xf bank_mask:0xf
  s_nop 1
  v_add_f32_dpp v77, v77, v77 quad_perm:[2,3,0,1] row_mask:0xf bank_mask:0xf
  s_nop 1
  v_add_f32_dpp v77, v77, v77 row_ror:4 row_mask:0xf bank_mask:0xf
  s_nop 1
  v_add_f32_dpp v77, v77, v77 row_ror:8 row_mask:0xf bank_mask:0xf
  v_mov_b32 v78, v77
  s_nop 1
  v_permlane16_swap_b32 v77, v78
  v_add_f32 v77, v77, v78
  v_mov_b32 v78, v77
  s_nop 1
  v_permlane32_swap_b32 v77, v78
  v_add_f32 v77, v77, v78
  v_mul_f32 v77, 0x3b000000, v77
  v_cvt_pk_bf16_f32 v78, v76, v77
  v_lshlrev_b32 v76, 16, v78
  v_and_b32 v77, 0xffff0000, v78
  v_mov_b32 v72, v76
  v_add_f32 v77, 0x3727c5ac, v77
  v_cvt_pk_bf16_f32 v77, v77, v77
  v_lshlrev_b32 v77, 16, v77
  v_sqrt_f32 v77, v77
  s_nop 0
  v_cvt_pk_bf16_f32 v77, v77, v77
  v_lshlrev_b32 v77, 16, v77
  v_mov_b32 v73, v77
  v_rcp_f32 v74, v77
  s_waitcnt vmcnt(7)
  v_lshlrev_b32 v48, 16, v48
  v_lshlrev_b32 v49, 16, v49
  v_lshlrev_b32 v50, 16, v50
  v_mov_b32 v51, 0
  v_sub_f32 v48, v48, v72
  v_sub_f32 v49, v49, v72
  v_cvt_pk_bf16_f32 v76, v48, v49
  v_lshlrev_b32 v48, 16, v76
  v_and_b32 v49, 0xffff0000, v76
  v_mul_f32 v77, v48, v74
  v_mul_f32 v78, v49, v74
  v_fma_f32 v48, -v77, v73, v48
  v_fma_f32 v49, -v78, v73, v49
  v_fma_f32 v48, v48, v74, v77
  v_fma_f32 v49, v49, v74, v78
  v_cvt_pk_bf16_f32 v76, v48, v49
  v_lshlrev_b32 v48, 16, v76
  v_and_b32 v49, 0xffff0000, v76
  v_sub_f32 v50, v50, v72
  v_sub_f32 v51, v51, v72
  v_cvt_pk_bf16_f32 v76, v50, v51
  v_lshlrev_b32 v50, 16, v76
  v_and_b32 v51, 0xffff0000, v76
  v_mul_f32 v77, v50, v74
  v_mul_f32 v78, v51, v74
  v_fma_f32 v50, -v77, v73, v50
  v_fma_f32 v51, -v78, v73, v51
  v_fma_f32 v50, v50, v74, v77
  v_fma_f32 v51, v51, v74, v78
  v_cvt_pk_bf16_f32 v76, v50, v51
  v_lshlrev_b32 v50, 16, v76
  v_and_b32 v51, 0xffff0000, v76
  v_lshrrev_b32 v44, 16, v48
  v_lshrrev_b32 v45, 16, v49
  v_lshrrev_b32 v46, 16, v50
  s_waitcnt vmcnt(4)
  v_dot2_f32_bf16 v64, v52, v44, 0
  v_dot2_f32_bf16 v65, v52, v48, 0
  v_dot2_f32_bf16 v66, v53, v44, 0
  v_dot2_f32_bf16 v67, v53, v48, 0
  v_dot2_f32_bf16 v68, v54, v44, 0
  v_dot2_f32_bf16 v69, v54, v48, 0
  v_dot2_f32_bf16 v70, v55, v44, 0
  v_dot2_f32_bf16 v71, v55, v48, 0
  v_dot2_f32_bf16 v64, v56, v45, v64
  v_dot2_f32_bf16 v65, v56, v49, v65
  v_dot2_f32_bf16 v66, v57, v45, v66
  v_dot2_f32_bf16 v67, v57, v49, v67
  v_dot2_f32_bf16 v68, v58, v45, v68
  v_dot2_f32_bf16 v69, v58, v49, v69
  v_dot2_f32_bf16 v70, v59, v45, v70
  v_dot2_f32_bf16 v71, v59, v49, v71
  v_dot2_f32_bf16 v64, v60, v46, v64
  v_dot2_f32_bf16 v65, v60, v50, v65
  v_dot2_f32_bf16 v66, v61, v46, v66
  v_dot2_f32_bf16 v67, v61, v50, v67
  v_dot2_f32_bf16 v68, v62, v46, v68
  v_dot2_f32_bf16 v69, v62, v50, v69
  v_dot2_f32_bf16 v70, v63, v46, v70
  v_dot2_f32_bf16 v71, v63, v50, v71
  v_permlane32_swap_b32 v64, v68
  v_permlane32_swap_b32 v65, v69
  v_permlane32_swap_b32 v66, v70
  v_permlane32_swap_b32 v67, v71
  v_add_f32 v64, v64, v68
  v_add_f32 v65, v65, v69
  v_add_f32 v66, v66, v70
  v_add_f32 v67, v67, v71
  s_nop 0
  v_permlane16_swap_b32 v64, v66
  v_permlane16_swap_b32 v65, v67
  v_add_f32 v64, v64, v66
  v_add_f32 v65, v65, v67
  s_nop 0
  v_add_f32_dpp v64, v64, v64 row_ror:8 row_mask:0xf bank_mask:0x3
  s_nop 1
  v_add_f32_dpp v64, v65, v65 row_ror:8 row_mask:0xf bank_mask:0xc
  v_and_b32 v3, 7, v2
  v_lshlrev_b32 v3, 3, v3
  v_bfe_u32 v4, v2, 5, 1
  v_lshl_add_u32 v3, v4, 2, v3
  v_bfe_u32 v4, v2, 4, 1
  v_lshl_add_u32 v3, v4, 1, v3
  v_bfe_u32 v4, v2, 3, 1
  v_add_u32 v3, v3, v4
  s_lshl_b32 s86, s3, 8
  s_add_u32 s86, s86, 131072
  v_lshl_add_u32 v3, v3, 2, s86
  ds_write_b32 v3, v64
  s_waitcnt lgkmcnt(0)
  s_barrier
  v_lshrrev_b32 v3, 4, v2
  v_and_b32 v4, 15, v2
  v_xor_b32 v5, v4, v3
  v_lshlrev_b32 v5, 4, v5
  v_lshl_add_u32 v5, v4, 8, v5
  v_add_u32 v16, s42, v5
  v_xor_b32 v17, 64, v16
  v_xor_b32 v18, 128, v16
  v_xor_b32 v19, 192, v16
  v_lshrrev_b32 v5, 2, v2
  v_and_b32 v6, 7, v5
  v_lshlrev_b32 v6, 5, v6
  v_lshl_add_u32 v6, v5, 8, v6
  v_and_b32 v7, 3, v2
  v_lshl_add_u32 v6, v7, 3, v6
  v_add_u32 v20, s42, v6
  v_xor_b32 v21, 32, v20
  v_xor_b32 v22, 64, v20
  v_xor_b32 v23, 96, v20
  v_xor_b32 v24, 128, v20
  v_xor_b32 v25, 160, v20
  v_xor_b32 v26, 192, v20
  v_xor_b32 v27, 224, v20
  v_bfe_u32 v5, v2, 2, 1
  v_cvt_f32_u32 v5, v5
  v_sub_f32 v85, 0, v5
  v_mov_b32 v82, 0xff800000
  v_mov_b32 v83, 0xff800000
  v_mov_b32 v84, 0
  v_mov_b32 v100, 0
  v_mov_b32 v101, 0
  v_mov_b32 v102, 0
  v_mov_b32 v103, 0
  v_mov_b32 v104, 0
  v_mov_b32 v105, 0
  v_mov_b32 v106, 0
  v_mov_b32 v107, 0
  v_mov_b32 v108, 0
  v_mov_b32 v109, 0
  v_mov_b32 v110, 0
  v_mov_b32 v111, 0
  v_mov_b32 v112, 0
  v_mov_b32 v113, 0
  v_mov_b32 v114, 0
  v_mov_b32 v115, 0
  v_mov_b32 v116, 0
  v_mov_b32 v117, 0
  v_mov_b32 v118, 0
  v_mov_b32 v119, 0
  v_mov_b32 v120, 0
  v_mov_b32 v121, 0
  v_mov_b32 v122, 0
  v_mov_b32 v123, 0
  v_mov_b32 v124, 0
  v_mov_b32 v125, 0
  v_mov_b32 v126, 0
  v_mov_b32 v127, 0
  v_mov_b32 v128, 0
  v_mov_b32 v129, 0
  v_mov_b32 v130, 0
  v_mov_b32 v131, 0
  s_mov_b32 s47, 0x3fb8aa3b
  v_lshrrev_b32 v86, 4, v2
  v_lshlrev_b32 v86, 4, v86
  s_lshl_b32 s86, s3, 5
  v_xor_b32 v86, s86, v86
  v_and_b32 v87, 3, v2
  v_lshl_add_u32 v86, v87, 9, v86
  v_add_u32 v134, s42, v86
  v_xor_b32 v135, 64, v134
  v_xor_b32 v136, 128, v134
  v_xor_b32 v137, 192, v134
  s_add_u32 s86, s86, s42
  s_add_u32 s86, s86, 2048
  v_lshlrev_b32 v87, 3, v87
  v_add_u32 v138, s86, v87
  v_and_b32 v86, 7, v2
  v_lshrrev_b32 v87, 3, v2
  v_xor_b32 v88, v86, v87
  v_lshlrev_b32 v88, 5, v88
  v_lshl_add_u32 v88, v86, 14, v88
  s_lshl_b32 s86, s3, 8
  v_add_u32 v139, s86, v88
  s_lshr_b32 s87, s3, 1
  s_lshl_b32 s86, s87, 3
  s_add_u32 s86, s86, 2048
  v_mul_u32_u24 v88, 16416, v86
  v_add_u32 v140, s86, v88
  s_mul_i32 s88, s80, 24
  s_add_u32 s88, s88, s81
  s_lshl_b32 s86, s88, 10
  s_lshl_b32 s89, s3, 7
  s_add_u32 s86, s86, s89
  s_add_u32 s86, s86, 1048576
  v_lshlrev_b32 v88, 4, v87
  v_add_u32 v141, s86, v88
  v_bfe_u32 v88, v2, 2, 1
  v_lshl_add_u32 v141, v88, 3, v141
  s_lshl_b32 s86, s88, 5
  s_lshl_b32 s87, s87, 3
  s_add_u32 s86, s86, s87
  s_add_u32 s86, s86, 65536
  s_bitcmp0_b32 s3, 0
  s_cselect_b32 s86, s86, 0x7ffffff0
  v_mov_b32 v142, s86
  v_and_b32 v5, 3, v2
  v_lshlrev_b32 v5, 8, v5
  v_lshrrev_b32 v6, 4, v2
  v_lshl_add_u32 v5, v6, 4, v5
  v_add_u32 v5, 133120, v5
  s_and_b32 s86, s3, 3
  s_lshl_b32 s87, s80, 2
  s_add_u32 s87, s87, s86
  s_lshl_b32 s90, s87, 8
  s_add_u32 s90, s90, 196608
  s_lshl_b32 s91, s80, 24
  s_lshl_b32 s86, s86, 12
  s_add_u32 s91, s91, s86
  s_add_u32 s91, s91, 15728640
  s_barrier
  s_mov_b32 m0, s43
  s_nop 0
  buffer_load_dwordx4 v14, s[8:11], s41 offen offset:0 nt lds
  buffer_load_dwordx4 v15, s[8:11], s41 offen offset:1024 nt lds
  buffer_load_dwordx4 v14, s[8:11], s41 offen offset:2048 nt lds
  buffer_load_dwordx4 v15, s[8:11], s41 offen offset:3072 nt lds
  s_add_u32 s41, s41, 0x4000
  s_mov_b32 m0, s44
  s_nop 0
  buffer_load_dwordx4 v10, s[4:7], s40 offen offset:0 nt lds
  buffer_load_dwordx4 v11, s[4:7], s40 offen offset:1024 nt lds
  buffer_load_dwordx4 v12, s[4:7], s40 offen offset:2048 nt lds
  buffer_load_dwordx4 v13, s[4:7], s40 offen offset:3072 nt lds
  s_add_u32 s40, s40, 0x4000
  s_mov_b32 m0, s45
  s_nop 0
  buffer_load_dwordx4 v14, s[8:11], s41 offen offset:0 nt lds
  buffer_load_dwordx4 v15, s[8:11], s41 offen offset:1024 nt lds
  buffer_load_dwordx4 v14, s[8:11], s41 offen offset:2048 nt lds
  buffer_load_dwordx4 v15, s[8:11], s41 offen offset:3072 nt lds
  s_add_u32 s41, s41, 0x4000
  s_barrier
  ds_read_b128 v[28:31], v5 offset:0
  ds_read_b128 v[32:35], v5 offset:64
  ds_read_b128 v[36:39], v5 offset:128
  ds_read_b128 v[40:43], v5 offset:192
  s_waitcnt lgkmcnt(0)
  s_waitcnt vmcnt(12)
  ds_read_b128 v[44:47], v16 offset:0
  ds_read_b128 v[48:51], v17 offset:0
  ds_read_b128 v[52:55], v18 offset:0
  ds_read_b128 v[56:59], v19 offset:0
  s_waitcnt lgkmcnt(0)
  v_mfma_f32_16x16x32_bf16 v[76:79], v[44:47], v[28:31], 0
  v_mfma_f32_16x16x32_bf16 v[76:79], v[48:51], v[32:35], v[76:79]
  v_mfma_f32_16x16x32_bf16 v[76:79], v[52:55], v[36:39], v[76:79]
  v_mfma_f32_16x16x32_bf16 v[76:79], v[56:59], v[40:43], v[76:79]
  s_mov_b32 m0, s42
  s_nop 0
  buffer_load_dwordx4 v10, s[4:7], s40 offen offset:0 nt lds
  buffer_load_dwordx4 v11, s[4:7], s40 offen offset:1024 nt lds
  buffer_load_dwordx4 v12, s[4:7], s40 offen offset:2048 nt lds
  buffer_load_dwordx4 v13, s[4:7], s40 offen offset:3072 nt lds
  s_add_u32 s40, s40, 0x4000
  s_nop 0
  v_cvt_pk_bf16_f32 v86, v76, v77
  v_cvt_pk_bf16_f32 v87, v78, v79
  v_lshlrev_b32 v76, 16, v86
  v_and_b32 v77, 0xffff0000, v86
  v_lshlrev_b32 v78, 16, v87
  v_and_b32 v79, 0xffff0000, v87
  v_mul_f32 v76, 0x3db504f3, v76
  v_mul_f32 v77, 0x3db504f3, v77
  v_mul_f32 v78, 0x3db504f3, v78
  v_mul_f32 v79, 0x3db504f3, v79
  v_cvt_pk_bf16_f32 v86, v76, v77
  v_cvt_pk_bf16_f32 v87, v78, v79
  v_lshlrev_b32 v76, 16, v86
  v_and_b32 v77, 0xffff0000, v86
  v_lshlrev_b32 v78, 16, v87
  v_and_b32 v79, 0xffff0000, v87
  v_max3_f32 v88, v76, v77, v78
  v_max3_f32 v88, v88, v79, v82
  v_mov_b32 v89, v88
  s_nop 1
  v_permlane16_swap_b32 v88, v89
  v_max_f32 v88, v88, v89
  v_mov_b32 v89, v88
  s_nop 1
  v_permlane32_swap_b32 v88, v89
  v_max_f32 v88, v88, v89
  v_mul_f32 v89, 0x3fb8aa3b, v88
  v_cmp_gt_f32 vcc, v88, v82
  v_fma_f32 v76, v76, s47, -v89
  v_fma_f32 v77, v77, s47, -v89
  v_fma_f32 v78, v78, s47, -v89
  v_fma_f32 v79, v79, s47, -v89
  v_exp_f32 v76, v76
  v_exp_f32 v77, v77
  v_exp_f32 v78, v78
  v_exp_f32 v79, v79
  s_cbranch_vccz noresc_101
  v_sub_f32 v90, v83, v89
  v_exp_f32 v90, v90
  v_mov_b32 v82, v88
  v_mov_b32 v83, v89
  v_mul_f32 v84, v84, v90
  v_mul_f32 v100, v100, v90
  v_mul_f32 v101, v101, v90
  v_mul_f32 v102, v102, v90
  v_mul_f32 v103, v103, v90
  v_mul_f32 v104, v104, v90
  v_mul_f32 v105, v105, v90
  v_mul_f32 v106, v106, v90
  v_mul_f32 v107, v107, v90
  v_mul_f32 v108, v108, v90
  v_mul_f32 v109, v109, v90
  v_mul_f32 v110, v110, v90
  v_mul_f32 v111, v111, v90
  v_mul_f32 v112, v112, v90
  v_mul_f32 v113, v113, v90
  v_mul_f32 v114, v114, v90
  v_mul_f32 v115, v115, v90
  v_mul_f32 v116, v116, v90
  v_mul_f32 v117, v117, v90
  v_mul_f32 v118, v118, v90
  v_mul_f32 v119, v119, v90
  v_mul_f32 v120, v120, v90
  v_mul_f32 v121, v121, v90
  v_mul_f32 v122, v122, v90
  v_mul_f32 v123, v123, v90
  v_mul_f32 v124, v124, v90
  v_mul_f32 v125, v125, v90
  v_mul_f32 v126, v126, v90
  v_mul_f32 v127, v127, v90
  v_mul_f32 v128, v128, v90
  v_mul_f32 v129, v129, v90
  v_mul_f32 v130, v130, v90
  v_mul_f32 v131, v131, v90
noresc_101:
  v_add_f32 v91, v76, v77
  v_add_f32 v92, v78, v79
  v_cvt_pk_bf16_f32 v86, v76, v77
  v_cvt_pk_bf16_f32 v87, v78, v79
  v_add_f32 v91, v91, v92
  v_lshlrev_b32 v93, 16, v86
  v_and_b32 v94, 0xffff0000, v86
  v_lshlrev_b32 v95, 16, v87
  v_and_b32 v96, 0xffff0000, v87
  v_add_f32 v84, v84, v91
  v_fma_f32 v76, v93, v85, v76
  v_fma_f32 v77, v94, v85, v77
  v_fma_f32 v78, v95, v85, v78
  v_fma_f32 v79, v96, v85, v79
  v_cvt_pk_bf16_f32 v80, v76, v77
  v_cvt_pk_bf16_f32 v81, v78, v79
  s_waitcnt vmcnt(12)
  ds_read_b64_tr_b16 v[60:61], v20 offset:4096
  ds_read_b64_tr_b16 v[62:63], v21 offset:4096
  ds_read_b64_tr_b16 v[64:65], v22 offset:4096
  ds_read_b64_tr_b16 v[66:67], v23 offset:4096
  ds_read_b64_tr_b16 v[68:69], v24 offset:4096
  ds_read_b64_tr_b16 v[70:71], v25 offset:4096
  ds_read_b64_tr_b16 v[72:73], v26 offset:4096
  ds_read_b64_tr_b16 v[74:75], v27 offset:4096
  s_waitcnt lgkmcnt(0)
  v_mfma_f32_16x16x16_bf16 v[100:103], v[60:61], v[80:81], v[100:103]
  v_mfma_f32_16x16x16_bf16 v[104:107], v[62:63], v[80:81], v[104:107]
  v_mfma_f32_16x16x16_bf16 v[108:111], v[64:65], v[80:81], v[108:111]
  v_mfma_f32_16x16x16_bf16 v[112:115], v[66:67], v[80:81], v[112:115]
  v_mfma_f32_16x16x16_bf16 v[116:119], v[68:69], v[80:81], v[116:119]
  v_mfma_f32_16x16x16_bf16 v[120:123], v[70:71], v[80:81], v[120:123]
  v_mfma_f32_16x16x16_bf16 v[124:127], v[72:73], v[80:81], v[124:127]
  v_mfma_f32_16x16x16_bf16 v[128:131], v[74:75], v[80:81], v[128:131]
  s_mov_b32 m0, s43
  s_nop 0
  buffer_load_dwordx4 v14, s[8:11], s41 offen offset:0 nt lds
  buffer_load_dwordx4 v15, s[8:11], s41 offen offset:1024 nt lds
  buffer_load_dwordx4 v14, s[8:11], s41 offen offset:2048 nt lds
  buffer_load_dwordx4 v15, s[8:11], s41 offen offset:3072 nt lds
  s_add_u32 s41, s41, 0x4000
  s_waitcnt vmcnt(12)
  ds_read_b128 v[44:47], v16 offset:8192
  ds_read_b128 v[48:51], v17 offset:8192
  ds_read_b128 v[52:55], v18 offset:8192
  ds_read_b128 v[56:59], v19 offset:8192
  s_waitcnt lgkmcnt(0)
  v_mfma_f32_16x16x32_bf16 v[76:79], v[44:47], v[28:31], 0
  v_mfma_f32_16x16x32_bf16 v[76:79], v[48:51], v[32:35], v[76:79]
  v_mfma_f32_16x16x32_bf16 v[76:79], v[52:55], v[36:39], v[76:79]
  v_mfma_f32_16x16x32_bf16 v[76:79], v[56:59], v[40:43], v[76:79]
  s_mov_b32 m0, s44
  s_nop 0
  buffer_load_dwordx4 v10, s[4:7], s40 offen offset:0 nt lds
  buffer_load_dwordx4 v11, s[4:7], s40 offen offset:1024 nt lds
  buffer_load_dwordx4 v12, s[4:7], s40 offen offset:2048 nt lds
  buffer_load_dwordx4 v13, s[4:7], s40 offen offset:3072 nt lds
  s_add_u32 s40, s40, 0x4000
  s_nop 0
  v_cvt_pk_bf16_f32 v86, v76, v77
  v_cvt_pk_bf16_f32 v87, v78, v79
  v_lshlrev_b32 v76, 16, v86
  v_and_b32 v77, 0xffff0000, v86
  v_lshlrev_b32 v78, 16, v87
  v_and_b32 v79, 0xffff0000, v87
  v_mul_f32 v76, 0x3db504f3, v76
  v_mul_f32 v77, 0x3db504f3, v77
  v_mul_f32 v78, 0x3db504f3, v78
  v_mul_f32 v79, 0x3db504f3, v79
  v_cvt_pk_bf16_f32 v86, v76, v77
  v_cvt_pk_bf16_f32 v87, v78, v79
  v_lshlrev_b32 v76, 16, v86
  v_and_b32 v77, 0xffff0000, v86
  v_lshlrev_b32 v78, 16, v87
  v_and_b32 v79, 0xffff0000, v87
  v_max3_f32 v88, v76, v77, v78
  v_max3_f32 v88, v88, v79, v82
  v_mov_b32 v89, v88
  s_nop 1
  v_permlane16_swap_b32 v88, v89
  v_max_f32 v88, v88, v89
  v_mov_b32 v89, v88
  s_nop 1
  v_permlane32_swap_b32 v88, v89
  v_max_f32 v88, v88, v89
  v_mul_f32 v89, 0x3fb8aa3b, v88
  v_cmp_gt_f32 vcc, v88, v82
  v_fma_f32 v76, v76, s47, -v89
  v_fma_f32 v77, v77, s47, -v89
  v_fma_f32 v78, v78, s47, -v89
  v_fma_f32 v79, v79, s47, -v89
  v_exp_f32 v76, v76
  v_exp_f32 v77, v77
  v_exp_f32 v78, v78
  v_exp_f32 v79, v79
  s_cbranch_vccz noresc_202
  v_sub_f32 v90, v83, v89
  v_exp_f32 v90, v90
  v_mov_b32 v82, v88
  v_mov_b32 v83, v89
  v_mul_f32 v84, v84, v90
  v_mul_f32 v100, v100, v90
  v_mul_f32 v101, v101, v90
  v_mul_f32 v102, v102, v90
  v_mul_f32 v103, v103, v90
  v_mul_f32 v104, v104, v90
  v_mul_f32 v105, v105, v90
  v_mul_f32 v106, v106, v90
  v_mul_f32 v107, v107, v90
  v_mul_f32 v108, v108, v90
  v_mul_f32 v109, v109, v90
  v_mul_f32 v110, v110, v90
  v_mul_f32 v111, v111, v90
  v_mul_f32 v112, v112, v90
  v_mul_f32 v113, v113, v90
  v_mul_f32 v114, v114, v90
  v_mul_f32 v115, v115, v90
  v_mul_f32 v116, v116, v90
  v_mul_f32 v117, v117, v90
  v_mul_f32 v118, v118, v90
  v_mul_f32 v119, v119, v90
  v_mul_f32 v120, v120, v90
  v_mul_f32 v121, v121, v90
  v_mul_f32 v122, v122, v90
  v_mul_f32 v123, v123, v90
  v_mul_f32 v124, v124, v90
  v_mul_f32 v125, v125, v90
  v_mul_f32 v126, v126, v90
  v_mul_f32 v127, v127, v90
  v_mul_f32 v128, v128, v90
  v_mul_f32 v129, v129, v90
  v_mul_f32 v130, v130, v90
  v_mul_f32 v131, v131, v90
noresc_202:
  v_add_f32 v91, v76, v77
  v_add_f32 v92, v78, v79
  v_cvt_pk_bf16_f32 v86, v76, v77
  v_cvt_pk_bf16_f32 v87, v78, v79
  v_add_f32 v91, v91, v92
  v_lshlrev_b32 v93, 16, v86
  v_and_b32 v94, 0xffff0000, v86
  v_lshlrev_b32 v95, 16, v87
  v_and_b32 v96, 0xffff0000, v87
  v_add_f32 v84, v84, v91
  v_fma_f32 v76, v93, v85, v76
  v_fma_f32 v77, v94, v85, v77
  v_fma_f32 v78, v95, v85, v78
  v_fma_f32 v79, v96, v85, v79
  v_cvt_pk_bf16_f32 v80, v76, v77
  v_cvt_pk_bf16_f32 v81, v78, v79
  s_waitcnt vmcnt(12)
  ds_read_b64_tr_b16 v[60:61], v20 offset:12288
  ds_read_b64_tr_b16 v[62:63], v21 offset:12288
  ds_read_b64_tr_b16 v[64:65], v22 offset:12288
  ds_read_b64_tr_b16 v[66:67], v23 offset:12288
  ds_read_b64_tr_b16 v[68:69], v24 offset:12288
  ds_read_b64_tr_b16 v[70:71], v25 offset:12288
  ds_read_b64_tr_b16 v[72:73], v26 offset:12288
  ds_read_b64_tr_b16 v[74:75], v27 offset:12288
  s_waitcnt lgkmcnt(0)
  v_mfma_f32_16x16x16_bf16 v[100:103], v[60:61], v[80:81], v[100:103]
  v_mfma_f32_16x16x16_bf16 v[104:107], v[62:63], v[80:81], v[104:107]
  v_mfma_f32_16x16x16_bf16 v[108:111], v[64:65], v[80:81], v[108:111]
  v_mfma_f32_16x16x16_bf16 v[112:115], v[66:67], v[80:81], v[112:115]
  v_mfma_f32_16x16x16_bf16 v[116:119], v[68:69], v[80:81], v[116:119]
  v_mfma_f32_16x16x16_bf16 v[120:123], v[70:71], v[80:81], v[120:123]
  v_mfma_f32_16x16x16_bf16 v[124:127], v[72:73], v[80:81], v[124:127]
  v_mfma_f32_16x16x16_bf16 v[128:131], v[74:75], v[80:81], v[128:131]
  s_mov_b32 m0, s45
  s_nop 0
  buffer_load_dwordx4 v14, s[8:11], s41 offen offset:0 nt lds
  buffer_load_dwordx4 v15, s[8:11], s41 offen offset:1024 nt lds
  buffer_load_dwordx4 v14, s[8:11], s41 offen offset:2048 nt lds
  buffer_load_dwordx4 v15, s[8:11], s41 offen offset:3072 nt lds
  s_add_u32 s41, s41, 0x4000
  s_cmp_lt_u32 s3, 4
  s_cselect_b32 s46, 9, 6
attloop_203:
  s_waitcnt vmcnt(12)
  ds_read_b128 v[44:47], v16 offset:0
  ds_read_b128 v[48:51], v17 offset:0
  ds_read_b128 v[52:55], v18 offset:0
  ds_read_b128 v[56:59], v19 offset:0
  s_waitcnt lgkmcnt(0)
  v_mfma_f32_16x16x32_bf16 v[76:79], v[44:47], v[28:31], 0
  v_mfma_f32_16x16x32_bf16 v[76:79], v[48:51], v[32:35], v[76:79]
  v_mfma_f32_16x16x32_bf16 v[76:79], v[52:55], v[36:39], v[76:79]
  v_mfma_f32_16x16x32_bf16 v[76:79], v[56:59], v[40:43], v[76:79]
  s_mov_b32 m0, s42
  s_nop 0
  buffer_load_dwordx4 v10, s[4:7], s40 offen offset:0 nt lds
  buffer_load_dwordx4 v11, s[4:7], s40 offen offset:1024 nt lds
  buffer_load_dwordx4 v12, s[4:7], s40 offen offset:2048 nt lds
  buffer_load_dwordx4 v13, s[4:7], s40 offen offset:3072 nt lds
  s_add_u32 s40, s40, 0x4000
  s_nop 0
  v_cvt_pk_bf16_f32 v86, v76, v77
  v_cvt_pk_bf16_f32 v87, v78, v79
  v_lshlrev_b32 v76, 16, v86
  v_and_b32 v77, 0xffff0000, v86
  v_lshlrev_b32 v78, 16, v87
  v_and_b32 v79, 0xffff0000, v87
  v_mul_f32 v76, 0x3db504f3, v76
  v_mul_f32 v77, 0x3db504f3, v77
  v_mul_f32 v78, 0x3db504f3, v78
  v_mul_f32 v79, 0x3db504f3, v79
  v_cvt_pk_bf16_f32 v86, v76, v77
  v_cvt_pk_bf16_f32 v87, v78, v79
  v_lshlrev_b32 v76, 16, v86
  v_and_b32 v77, 0xffff0000, v86
  v_lshlrev_b32 v78, 16, v87
  v_and_b32 v79, 0xffff0000, v87
  v_max3_f32 v88, v76, v77, v78
  v_max3_f32 v88, v88, v79, v82
  v_mov_b32 v89, v88
  s_nop 1
  v_permlane16_swap_b32 v88, v89
  v_max_f32 v88, v88, v89
  v_mov_b32 v89, v88
  s_nop 1
  v_permlane32_swap_b32 v88, v89
  v_max_f32 v88, v88, v89
  v_mul_f32 v89, 0x3fb8aa3b, v88
  v_cmp_gt_f32 vcc, v88, v82
  v_fma_f32 v76, v76, s47, -v89
  v_fma_f32 v77, v77, s47, -v89
  v_fma_f32 v78, v78, s47, -v89
  v_fma_f32 v79, v79, s47, -v89
  v_exp_f32 v76, v76
  v_exp_f32 v77, v77
  v_exp_f32 v78, v78
  v_exp_f32 v79, v79
  s_cbranch_vccz noresc_304
  v_sub_f32 v90, v83, v89
  v_exp_f32 v90, v90
  v_mov_b32 v82, v88
  v_mov_b32 v83, v89
  v_mul_f32 v84, v84, v90
  v_mul_f32 v100, v100, v90
  v_mul_f32 v101, v101, v90
  v_mul_f32 v102, v102, v90
  v_mul_f32 v103, v103, v90
  v_mul_f32 v104, v104, v90
  v_mul_f32 v105, v105, v90
  v_mul_f32 v106, v106, v90
  v_mul_f32 v107, v107, v90
  v_mul_f32 v108, v108, v90
  v_mul_f32 v109, v109, v90
  v_mul_f32 v110, v110, v90
  v_mul_f32 v111, v111, v90
  v_mul_f32 v112, v112, v90
  v_mul_f32 v113, v113, v90
  v_mul_f32 v114, v114, v90
  v_mul_f32 v115, v115, v90
  v_mul_f32 v116, v116, v90
  v_mul_f32 v117, v117, v90
  v_mul_f32 v118, v118, v90
  v_mul_f32 v119, v119, v90
  v_mul_f32 v120, v120, v90
  v_mul_f32 v121, v121, v90
  v_mul_f32 v122, v122, v90
  v_mul_f32 v123, v123, v90
  v_mul_f32 v124, v124, v90
  v_mul_f32 v125, v125, v90
  v_mul_f32 v126, v126, v90
  v_mul_f32 v127, v127, v90
  v_mul_f32 v128, v128, v90
  v_mul_f32 v129, v129, v90
  v_mul_f32 v130, v130, v90
  v_mul_f32 v131, v131, v90
noresc_304:
  v_add_f32 v91, v76, v77
  v_add_f32 v92, v78, v79
  v_cvt_pk_bf16_f32 v86, v76, v77
  v_cvt_pk_bf16_f32 v87, v78, v79
  v_add_f32 v91, v91, v92
  v_lshlrev_b32 v93, 16, v86
  v_and_b32 v94, 0xffff0000, v86
  v_lshlrev_b32 v95, 16, v87
  v_and_b32 v96, 0xffff0000, v87
  v_add_f32 v84, v84, v91
  v_fma_f32 v76, v93, v85, v76
  v_fma_f32 v77, v94, v85, v77
  v_fma_f32 v78, v95, v85, v78
  v_fma_f32 v79, v96, v85, v79
  v_cvt_pk_bf16_f32 v80, v76, v77
  v_cvt_pk_bf16_f32 v81, v78, v79
  s_waitcnt vmcnt(12)
  ds_read_b64_tr_b16 v[60:61], v20 offset:4096
  ds_read_b64_tr_b16 v[62:63], v21 offset:4096
  ds_read_b64_tr_b16 v[64:65], v22 offset:4096
  ds_read_b64_tr_b16 v[66:67], v23 offset:4096
  ds_read_b64_tr_b16 v[68:69], v24 offset:4096
  ds_read_b64_tr_b16 v[70:71], v25 offset:4096
  ds_read_b64_tr_b16 v[72:73], v26 offset:4096
  ds_read_b64_tr_b16 v[74:75], v27 offset:4096
  s_waitcnt lgkmcnt(0)
  v_mfma_f32_16x16x16_bf16 v[100:103], v[60:61], v[80:81], v[100:103]
  v_mfma_f32_16x16x16_bf16 v[104:107], v[62:63], v[80:81], v[104:107]
  v_mfma_f32_16x16x16_bf16 v[108:111], v[64:65], v[80:81], v[108:111]
  v_mfma_f32_16x16x16_bf16 v[112:115], v[66:67], v[80:81], v[112:115]
  v_mfma_f32_16x16x16_bf16 v[116:119], v[68:69], v[80:81], v[116:119]
  v_mfma_f32_16x16x16_bf16 v[120:123], v[70:71], v[80:81], v[120:123]
  v_mfma_f32_16x16x16_bf16 v[124:127], v[72:73], v[80:81], v[124:127]
  v_mfma_f32_16x16x16_bf16 v[128:131], v[74:75], v[80:81], v[128:131]
  s_mov_b32 m0, s43
  s_nop 0
  buffer_load_dwordx4 v14, s[8:11], s41 offen offset:0 nt lds
  buffer_load_dwordx4 v15, s[8:11], s41 offen offset:1024 nt lds
  buffer_load_dwordx4 v14, s[8:11], s41 offen offset:2048 nt lds
  buffer_load_dwordx4 v15, s[8:11], s41 offen offset:3072 nt lds
  s_add_u32 s41, s41, 0x4000
  s_waitcnt vmcnt(12)
  ds_read_b128 v[44:47], v16 offset:8192
  ds_read_b128 v[48:51], v17 offset:8192
  ds_read_b128 v[52:55], v18 offset:8192
  ds_read_b128 v[56:59], v19 offset:8192
  s_waitcnt lgkmcnt(0)
  v_mfma_f32_16x16x32_bf16 v[76:79], v[44:47], v[28:31], 0
  v_mfma_f32_16x16x32_bf16 v[76:79], v[48:51], v[32:35], v[76:79]
  v_mfma_f32_16x16x32_bf16 v[76:79], v[52:55], v[36:39], v[76:79]
  v_mfma_f32_16x16x32_bf16 v[76:79], v[56:59], v[40:43], v[76:79]
  s_mov_b32 m0, s44
  s_nop 0
  buffer_load_dwordx4 v10, s[4:7], s40 offen offset:0 nt lds
  buffer_load_dwordx4 v11, s[4:7], s40 offen offset:1024 nt lds
  buffer_load_dwordx4 v12, s[4:7], s40 offen offset:2048 nt lds
  buffer_load_dwordx4 v13, s[4:7], s40 offen offset:3072 nt lds
  s_add_u32 s40, s40, 0x4000
  s_nop 0
  v_cvt_pk_bf16_f32 v86, v76, v77
  v_cvt_pk_bf16_f32 v87, v78, v79
  v_lshlrev_b32 v76, 16, v86
  v_and_b32 v77, 0xffff0000, v86
  v_lshlrev_b32 v78, 16, v87
  v_and_b32 v79, 0xffff0000, v87
  v_mul_f32 v76, 0x3db504f3, v76
  v_mul_f32 v77, 0x3db504f3, v77
  v_mul_f32 v78, 0x3db504f3, v78
  v_mul_f32 v79, 0x3db504f3, v79
  v_cvt_pk_bf16_f32 v86, v76, v77
  v_cvt_pk_bf16_f32 v87, v78, v79
  v_lshlrev_b32 v76, 16, v86
  v_and_b32 v77, 0xffff0000, v86
  v_lshlrev_b32 v78, 16, v87
  v_and_b32 v79, 0xffff0000, v87
  v_max3_f32 v88, v76, v77, v78
  v_max3_f32 v88, v88, v79, v82
  v_mov_b32 v89, v88
  s_nop 1
  v_permlane16_swap_b32 v88, v89
  v_max_f32 v88, v88, v89
  v_mov_b32 v89, v88
  s_nop 1
  v_permlane32_swap_b32 v88, v89
  v_max_f32 v88, v88, v89
  v_mul_f32 v89, 0x3fb8aa3b, v88
  v_cmp_gt_f32 vcc, v88, v82
  v_fma_f32 v76, v76, s47, -v89
  v_fma_f32 v77, v77, s47, -v89
  v_fma_f32 v78, v78, s47, -v89
  v_fma_f32 v79, v79, s47, -v89
  v_exp_f32 v76, v76
  v_exp_f32 v77, v77
  v_exp_f32 v78, v78
  v_exp_f32 v79, v79
  s_cbranch_vccz noresc_405
  v_sub_f32 v90, v83, v89
  v_exp_f32 v90, v90
  v_mov_b32 v82, v88
  v_mov_b32 v83, v89
  v_mul_f32 v84, v84, v90
  v_mul_f32 v100, v100, v90
  v_mul_f32 v101, v101, v90
  v_mul_f32 v102, v102, v90
  v_mul_f32 v103, v103, v90
  v_mul_f32 v104, v104, v90
  v_mul_f32 v105, v105, v90
  v_mul_f32 v106, v106, v90
  v_mul_f32 v107, v107, v90
  v_mul_f32 v108, v108, v90
  v_mul_f32 v109, v109, v90
  v_mul_f32 v110, v110, v90
  v_mul_f32 v111, v111, v90
  v_mul_f32 v112, v112, v90
  v_mul_f32 v113, v113, v90
  v_mul_f32 v114, v114, v90
  v_mul_f32 v115, v115, v90
  v_mul_f32 v116, v116, v90
  v_mul_f32 v117, v117, v90
  v_mul_f32 v118, v118, v90
  v_mul_f32 v119, v119, v90
  v_mul_f32 v120, v120, v90
  v_mul_f32 v121, v121, v90
  v_mul_f32 v122, v122, v90
  v_mul_f32 v123, v123, v90
  v_mul_f32 v124, v124, v90
  v_mul_f32 v125, v125, v90
  v_mul_f32 v126, v126, v90
  v_mul_f32 v127, v127, v90
  v_mul_f32 v128, v128, v90
  v_mul_f32 v129, v129, v90
  v_mul_f32 v130, v130, v90
  v_mul_f32 v131, v131, v90
noresc_405:
  v_add_f32 v91, v76, v77
  v_add_f32 v92, v78, v79
  v_cvt_pk_bf16_f32 v86, v76, v77
  v_cvt_pk_bf16_f32 v87, v78, v79
  v_add_f32 v91, v91, v92
  v_lshlrev_b32 v93, 16, v86
  v_and_b32 v94, 0xffff0000, v86
  v_lshlrev_b32 v95, 16, v87
  v_and_b32 v96, 0xffff0000, v87
  v_add_f32 v84, v84, v91
  v_fma_f32 v76, v93, v85, v76
  v_fma_f32 v77, v94, v85, v77
  v_fma_f32 v78, v95, v85, v78
  v_fma_f32 v79, v96, v85, v79
  v_cvt_pk_bf16_f32 v80, v76, v77
  v_cvt_pk_bf16_f32 v81, v78, v79
  s_waitcnt vmcnt(12)
  ds_read_b64_tr_b16 v[60:61], v20 offset:12288
  ds_read_b64_tr_b16 v[62:63], v21 offset:12288
  ds_read_b64_tr_b16 v[64:65], v22 offset:12288
  ds_read_b64_tr_b16 v[66:67], v23 offset:12288
  ds_read_b64_tr_b16 v[68:69], v24 offset:12288
  ds_read_b64_tr_b16 v[70:71], v25 offset:12288
  ds_read_b64_tr_b16 v[72:73], v26 offset:12288
  ds_read_b64_tr_b16 v[74:75], v27 offset:12288
  s_waitcnt lgkmcnt(0)
  v_mfma_f32_16x16x16_bf16 v[100:103], v[60:61], v[80:81], v[100:103]
  v_mfma_f32_16x16x16_bf16 v[104:107], v[62:63], v[80:81], v[104:107]
  v_mfma_f32_16x16x16_bf16 v[108:111], v[64:65], v[80:81], v[108:111]
  v_mfma_f32_16x16x16_bf16 v[112:115], v[66:67], v[80:81], v[112:115]
  v_mfma_f32_16x16x16_bf16 v[116:119], v[68:69], v[80:81], v[116:119]
  v_mfma_f32_16x16x16_bf16 v[120:123], v[70:71], v[80:81], v[120:123]
  v_mfma_f32_16x16x16_bf16 v[124:127], v[72:73], v[80:81], v[124:127]
  v_mfma_f32_16x16x16_bf16 v[128:131], v[74:75], v[80:81], v[128:131]
  s_mov_b32 m0, s45
  s_nop 0
  buffer_load_dwordx4 v14, s[8:11], s41 offen offset:0 nt lds
  buffer_load_dwordx4 v15, s[8:11], s41 offen offset:1024 nt lds
  buffer_load_dwordx4 v14, s[8:11], s41 offen offset:2048 nt lds
  buffer_load_dwordx4 v15, s[8:11], s41 offen offset:3072 nt lds
  s_add_u32 s41, s41, 0x4000
  s_sub_u32 s46, s46, 1
  s_cmp_lg_u32 s46, 0
  s_cbranch_scc1 attloop_203
  s_cmp_ge_u32 s3, 4
  s_cbranch_scc1 L_dyn
  s_waitcnt vmcnt(12)
  ds_read_b128 v[44:47], v16 offset:0
  ds_read_b128 v[48:51], v17 offset:0
  ds_read_b128 v[52:55], v18 offset:0
  ds_read_b128 v[56:59], v19 offset:0
  s_waitcnt lgkmcnt(0)
  v_mfma_f32_16x16x32_bf16 v[76:79], v[44:47], v[28:31], 0
  v_mfma_f32_16x16x32_bf16 v[76:79], v[48:51], v[32:35], v[76:79]
  v_mfma_f32_16x16x32_bf16 v[76:79], v[52:55], v[36:39], v[76:79]
  v_mfma_f32_16x16x32_bf16 v[76:79], v[56:59], v[40:43], v[76:79]
  s_nop 7
  v_cvt_pk_bf16_f32 v86, v76, v77
  v_cvt_pk_bf16_f32 v87, v78, v79
  v_lshlrev_b32 v76, 16, v86
  v_and_b32 v77, 0xffff0000, v86
  v_lshlrev_b32 v78, 16, v87
  v_and_b32 v79, 0xffff0000, v87
  v_mul_f32 v76, 0x3db504f3, v76
  v_mul_f32 v77, 0x3db504f3, v77
  v_mul_f32 v78, 0x3db504f3, v78
  v_mul_f32 v79, 0x3db504f3, v79
  v_cvt_pk_bf16_f32 v86, v76, v77
  v_cvt_pk_bf16_f32 v87, v78, v79
  v_lshlrev_b32 v76, 16, v86
  v_and_b32 v77, 0xffff0000, v86
  v_lshlrev_b32 v78, 16, v87
  v_and_b32 v79, 0xffff0000, v87
  v_max3_f32 v88, v76, v77, v78
  v_max3_f32 v88, v88, v79, v82
  v_mov_b32 v89, v88
  s_nop 1
  v_permlane16_swap_b32 v88, v89
  v_max_f32 v88, v88, v89
  v_mov_b32 v89, v88
  s_nop 1
  v_permlane32_swap_b32 v88, v89
  v_max_f32 v88, v88, v89
  v_mul_f32 v89, 0x3fb8aa3b, v88
  v_cmp_gt_f32 vcc, v88, v82
  v_fma_f32 v76, v76, s47, -v89
  v_fma_f32 v77, v77, s47, -v89
  v_fma_f32 v78, v78, s47, -v89
  v_fma_f32 v79, v79, s47, -v89
  v_exp_f32 v76, v76
  v_exp_f32 v77, v77
  v_exp_f32 v78, v78
  v_exp_f32 v79, v79
  s_cbranch_vccz noresc_506
  v_sub_f32 v90, v83, v89
  v_exp_f32 v90, v90
  v_mov_b32 v82, v88
  v_mov_b32 v83, v89
  v_mul_f32 v84, v84, v90
  v_mul_f32 v100, v100, v90
  v_mul_f32 v101, v101, v90
  v_mul_f32 v102, v102, v90
  v_mul_f32 v103, v103, v90
  v_mul_f32 v104, v104, v90
  v_mul_f32 v105, v105, v90
  v_mul_f32 v106, v106, v90
  v_mul_f32 v107, v107, v90
  v_mul_f32 v108, v108, v90
  v_mul_f32 v109, v109, v90
  v_mul_f32 v110, v110, v90
  v_mul_f32 v111, v111, v90
  v_mul_f32 v112, v112, v90
  v_mul_f32 v113, v113, v90
  v_mul_f32 v114, v114, v90
  v_mul_f32 v115, v115, v90
  v_mul_f32 v116, v116, v90
  v_mul_f32 v117, v117, v90
  v_mul_f32 v118, v118, v90
  v_mul_f32 v119, v119, v90
  v_mul_f32 v120, v120, v90
  v_mul_f32 v121, v121, v90
  v_mul_f32 v122, v122, v90
  v_mul_f32 v123, v123, v90
  v_mul_f32 v124, v124, v90
  v_mul_f32 v125, v125, v90
  v_mul_f32 v126, v126, v90
  v_mul_f32 v127, v127, v90
  v_mul_f32 v128, v128, v90
  v_mul_f32 v129, v129, v90
  v_mul_f32 v130, v130, v90
  v_mul_f32 v131, v131, v90
noresc_506:
  v_add_f32 v91, v76, v77
  v_add_f32 v92, v78, v79
  v_cvt_pk_bf16_f32 v86, v76, v77
  v_cvt_pk_bf16_f32 v87, v78, v79
  v_add_f32 v91, v91, v92
  v_lshlrev_b32 v93, 16, v86
  v_and_b32 v94, 0xffff0000, v86
  v_lshlrev_b32 v95, 16, v87
  v_and_b32 v96, 0xffff0000, v87
  v_add_f32 v84, v84, v91
  v_fma_f32 v76, v93, v85, v76
  v_fma_f32 v77, v94, v85, v77
  v_fma_f32 v78, v95, v85, v78
  v_fma_f32 v79, v96, v85, v79
  v_cvt_pk_bf16_f32 v80, v76, v77
  v_cvt_pk_bf16_f32 v81, v78, v79
  s_waitcnt vmcnt(8)
  ds_read_b64_tr_b16 v[60:61], v20 offset:4096
  ds_read_b64_tr_b16 v[62:63], v21 offset:4096
  ds_read_b64_tr_b16 v[64:65], v22 offset:4096
  ds_read_b64_tr_b16 v[66:67], v23 offset:4096
  ds_read_b64_tr_b16 v[68:69], v24 offset:4096
  ds_read_b64_tr_b16 v[70:71], v25 offset:4096
  ds_read_b64_tr_b16 v[72:73], v26 offset:4096
  ds_read_b64_tr_b16 v[74:75], v27 offset:4096
  s_waitcnt lgkmcnt(0)
  v_mfma_f32_16x16x16_bf16 v[100:103], v[60:61], v[80:81], v[100:103]
  v_mfma_f32_16x16x16_bf16 v[104:107], v[62:63], v[80:81], v[104:107]
  v_mfma_f32_16x16x16_bf16 v[108:111], v[64:65], v[80:81], v[108:111]
  v_mfma_f32_16x16x16_bf16 v[112:115], v[66:67], v[80:81], v[112:115]
  v_mfma_f32_16x16x16_bf16 v[116:119], v[68:69], v[80:81], v[116:119]
  v_mfma_f32_16x16x16_bf16 v[120:123], v[70:71], v[80:81], v[120:123]
  v_mfma_f32_16x16x16_bf16 v[124:127], v[72:73], v[80:81], v[124:127]
  v_mfma_f32_16x16x16_bf16 v[128:131], v[74:75], v[80:81], v[128:131]
  s_waitcnt vmcnt(4)
  ds_read_b128 v[44:47], v16 offset:8192
  ds_read_b128 v[48:51], v17 offset:8192
  ds_read_b128 v[52:55], v18 offset:8192
  ds_read_b128 v[56:59], v19 offset:8192
  s_waitcnt lgkmcnt(0)
  v_mfma_f32_16x16x32_bf16 v[76:79], v[44:47], v[28:31], 0
  v_mfma_f32_16x16x32_bf16 v[76:79], v[48:51], v[32:35], v[76:79]
  v_mfma_f32_16x16x32_bf16 v[76:79], v[52:55], v[36:39], v[76:79]
  v_mfma_f32_16x16x32_bf16 v[76:79], v[56:59], v[40:43], v[76:79]
  s_nop 7
  v_cvt_pk_bf16_f32 v86, v76, v77
  v_cvt_pk_bf16_f32 v87, v78, v79
  v_lshlrev_b32 v76, 16, v86
  v_and_b32 v77, 0xffff0000, v86
  v_lshlrev_b32 v78, 16, v87
  v_and_b32 v79, 0xffff0000, v87
  v_mul_f32 v76, 0x3db504f3, v76
  v_mul_f32 v77, 0x3db504f3, v77
  v_mul_f32 v78, 0x3db504f3, v78
  v_mul_f32 v79, 0x3db504f3, v79
  v_cvt_pk_bf16_f32 v86, v76, v77
  v_cvt_pk_bf16_f32 v87, v78, v79
  v_lshlrev_b32 v76, 16, v86
  v_and_b32 v77, 0xffff0000, v86
  v_lshlrev_b32 v78, 16, v87
  v_and_b32 v79, 0xffff0000, v87
  v_max3_f32 v88, v76, v77, v78
  v_max3_f32 v88, v88, v79, v82
  v_mov_b32 v89, v88
  s_nop 1
  v_permlane16_swap_b32 v88, v89
  v_max_f32 v88, v88, v89
  v_mov_b32 v89, v88
  s_nop 1
  v_permlane32_swap_b32 v88, v89
  v_max_f32 v88, v88, v89
  v_mul_f32 v89, 0x3fb8aa3b, v88
  v_cmp_gt_f32 vcc, v88, v82
  v_fma_f32 v76, v76, s47, -v89
  v_fma_f32 v77, v77, s47, -v89
  v_fma_f32 v78, v78, s47, -v89
  v_fma_f32 v79, v79, s47, -v89
  v_exp_f32 v76, v76
  v_exp_f32 v77, v77
  v_exp_f32 v78, v78
  v_exp_f32 v79, v79
  s_cbranch_vccz noresc_607
  v_sub_f32 v90, v83, v89
  v_exp_f32 v90, v90
  v_mov_b32 v82, v88
  v_mov_b32 v83, v89
  v_mul_f32 v84, v84, v90
  v_mul_f32 v100, v100, v90
  v_mul_f32 v101, v101, v90
  v_mul_f32 v102, v102, v90
  v_mul_f32 v103, v103, v90
  v_mul_f32 v104, v104, v90
  v_mul_f32 v105, v105, v90
  v_mul_f32 v106, v106, v90
  v_mul_f32 v107, v107, v90
  v_mul_f32 v108, v108, v90
  v_mul_f32 v109, v109, v90
  v_mul_f32 v110, v110, v90
  v_mul_f32 v111, v111, v90
  v_mul_f32 v112, v112, v90
  v_mul_f32 v113, v113, v90
  v_mul_f32 v114, v114, v90
  v_mul_f32 v115, v115, v90
  v_mul_f32 v116, v116, v90
  v_mul_f32 v117, v117, v90
  v_mul_f32 v118, v118, v90
  v_mul_f32 v119, v119, v90
  v_mul_f32 v120, v120, v90
  v_mul_f32 v121, v121, v90
  v_mul_f32 v122, v122, v90
  v_mul_f32 v123, v123, v90
  v_mul_f32 v124, v124, v90
  v_mul_f32 v125, v125, v90
  v_mul_f32 v126, v126, v90
  v_mul_f32 v127, v127, v90
  v_mul_f32 v128, v128, v90
  v_mul_f32 v129, v129, v90
  v_mul_f32 v130, v130, v90
  v_mul_f32 v131, v131, v90
noresc_607:
  v_add_f32 v91, v76, v77
  v_add_f32 v92, v78, v79
  v_cvt_pk_bf16_f32 v86, v76, v77
  v_cvt_pk_bf16_f32 v87, v78, v79
  v_add_f32 v91, v91, v92
  v_lshlrev_b32 v93, 16, v86
  v_and_b32 v94, 0xffff0000, v86
  v_lshlrev_b32 v95, 16, v87
  v_and_b32 v96, 0xffff0000, v87
  v_add_f32 v84, v84, v91
  v_fma_f32 v76, v93, v85, v76
  v_fma_f32 v77, v94, v85, v77
  v_fma_f32 v78, v95, v85, v78
  v_fma_f32 v79, v96, v85, v79
  v_cvt_pk_bf16_f32 v80, v76, v77
  v_cvt_pk_bf16_f32 v81, v78, v79
  s_waitcnt vmcnt(0)
  ds_read_b64_tr_b16 v[60:61], v20 offset:12288
  ds_read_b64_tr_b16 v[62:63], v21 offset:12288
  ds_read_b64_tr_b16 v[64:65], v22 offset:12288
  ds_read_b64_tr_b16 v[66:67], v23 offset:12288
  ds_read_b64_tr_b16 v[68:69], v24 offset:12288
  ds_read_b64_tr_b16 v[70:71], v25 offset:12288
  ds_read_b64_tr_b16 v[72:73], v26 offset:12288
  ds_read_b64_tr_b16 v[74:75], v27 offset:12288
  s_waitcnt lgkmcnt(0)
  v_mfma_f32_16x16x16_bf16 v[100:103], v[60:61], v[80:81], v[100:103]
  v_mfma_f32_16x16x16_bf16 v[104:107], v[62:63], v[80:81], v[104:107]
  v_mfma_f32_16x16x16_bf16 v[108:111], v[64:65], v[80:81], v[108:111]
  v_mfma_f32_16x16x16_bf16 v[112:115], v[66:67], v[80:81], v[112:115]
  v_mfma_f32_16x16x16_bf16 v[116:119], v[68:69], v[80:81], v[116:119]
  v_mfma_f32_16x16x16_bf16 v[120:123], v[70:71], v[80:81], v[120:123]
  v_mfma_f32_16x16x16_bf16 v[124:127], v[72:73], v[80:81], v[124:127]
  v_mfma_f32_16x16x16_bf16 v[128:131], v[74:75], v[80:81], v[128:131]
  s_branch L_attdone
L_dyn:
  s_waitcnt vmcnt(12)
  ds_read_b128 v[44:47], v16 offset:0
  ds_read_b128 v[48:51], v17 offset:0
  ds_read_b128 v[52:55], v18 offset:0
  ds_read_b128 v[56:59], v19 offset:0
  s_waitcnt lgkmcnt(0)
  v_mfma_f32_16x16x32_bf16 v[76:79], v[44:47], v[28:31], 0
  v_mfma_f32_16x16x32_bf16 v[76:79], v[48:51], v[32:35], v[76:79]
  v_mfma_f32_16x16x32_bf16 v[76:79], v[52:55], v[36:39], v[76:79]
  v_mfma_f32_16x16x32_bf16 v[76:79], v[56:59], v[40:43], v[76:79]
  s_mov_b32 m0, s42
  s_nop 0
  buffer_load_dwordx4 v10, s[4:7], s40 offen offset:0 nt lds
  buffer_load_dwordx4 v11, s[4:7], s40 offen offset:1024 nt lds
  buffer_load_dwordx4 v12, s[4:7], s40 offen offset:2048 nt lds
  buffer_load_dwordx4 v13, s[4:7], s40 offen offset:3072 nt lds
  v_mov_b32 v132, 1
  s_mov_b64 exec, 1
  buffer_atomic_add v132, off, s[12:15], s90 sc0 sc1
  s_mov_b64 exec, -1
  s_add_u32 s40, s40, 0x4000
  v_cvt_pk_bf16_f32 v86, v76, v77
  v_cvt_pk_bf16_f32 v87, v78, v79
  v_lshlrev_b32 v76, 16, v86
  v_and_b32 v77, 0xffff0000, v86
  v_lshlrev_b32 v78, 16, v87
  v_and_b32 v79, 0xffff0000, v87
  v_mul_f32 v76, 0x3db504f3, v76
  v_mul_f32 v77, 0x3db504f3, v77
  v_mul_f32 v78, 0x3db504f3, v78
  v_mul_f32 v79, 0x3db504f3, v79
  v_cvt_pk_bf16_f32 v86, v76, v77
  v_cvt_pk_bf16_f32 v87, v78, v79
  v_lshlrev_b32 v76, 16, v86
  v_and_b32 v77, 0xffff0000, v86
  v_lshlrev_b32 v78, 16, v87
  v_and_b32 v79, 0xffff0000, v87
  v_max3_f32 v88, v76, v77, v78
  v_max3_f32 v88, v88, v79, v82
  v_mov_b32 v89, v88
  s_nop 1
  v_permlane16_swap_b32 v88, v89
  v_max_f32 v88, v88, v89
  v_mov_b32 v89, v88
  s_nop 1
  v_permlane32_swap_b32 v88, v89
  v_max_f32 v88, v88, v89
  v_mul_f32 v89, 0x3fb8aa3b, v88
  v_cmp_gt_f32 vcc, v88, v82
  v_fma_f32 v76, v76, s47, -v89
  v_fma_f32 v77, v77, s47, -v89
  v_fma_f32 v78, v78, s47, -v89
  v_fma_f32 v79, v79, s47, -v89
  v_exp_f32 v76, v76
  v_exp_f32 v77, v77
  v_exp_f32 v78, v78
  v_exp_f32 v79, v79
  s_cbranch_vccz noresc_708
  v_sub_f32 v90, v83, v89
  v_exp_f32 v90, v90
  v_mov_b32 v82, v88
  v_mov_b32 v83, v89
  v_mul_f32 v84, v84, v90
  v_mul_f32 v100, v100, v90
  v_mul_f32 v101, v101, v90
  v_mul_f32 v102, v102, v90
  v_mul_f32 v103, v103, v90
  v_mul_f32 v104, v104, v90
  v_mul_f32 v105, v105, v90
  v_mul_f32 v106, v106, v90
  v_mul_f32 v107, v107, v90
  v_mul_f32 v108, v108, v90
  v_mul_f32 v109, v109, v90
  v_mul_f32 v110, v110, v90
  v_mul_f32 v111, v111, v90
  v_mul_f32 v112, v112, v90
  v_mul_f32 v113, v113, v90
  v_mul_f32 v114, v114, v90
  v_mul_f32 v115, v115, v90
  v_mul_f32 v116, v116, v90
  v_mul_f32 v117, v117, v90
  v_mul_f32 v118, v118, v90
  v_mul_f32 v119, v119, v90
  v_mul_f32 v120, v120, v90
  v_mul_f32 v121, v121, v90
  v_mul_f32 v122, v122, v90
  v_mul_f32 v123, v123, v90
  v_mul_f32 v124, v124, v90
  v_mul_f32 v125, v125, v90
  v_mul_f32 v126, v126, v90
  v_mul_f32 v127, v127, v90
  v_mul_f32 v128, v128, v90
  v_mul_f32 v129, v129, v90
  v_mul_f32 v130, v130, v90
  v_mul_f32 v131, v131, v90
noresc_708:
  v_add_f32 v91, v76, v77
  v_add_f32 v92, v78, v79
  v_cvt_pk_bf16_f32 v86, v76, v77
  v_cvt_pk_bf16_f32 v87, v78, v79
  v_add_f32 v91, v91, v92
  v_lshlrev_b32 v93, 16, v86
  v_and_b32 v94, 0xffff0000, v86
  v_lshlrev_b32 v95, 16, v87
  v_and_b32 v96, 0xffff0000, v87
  v_add_f32 v84, v84, v91
  v_fma_f32 v76, v93, v85, v76
  v_fma_f32 v77, v94, v85, v77
  v_fma_f32 v78, v95, v85, v78
  v_fma_f32 v79, v96, v85, v79
  v_cvt_pk_bf16_f32 v80, v76, v77
  v_cvt_pk_bf16_f32 v81, v78, v79
  s_waitcnt vmcnt(13)
  ds_read_b64_tr_b16 v[60:61], v20 offset:4096
  ds_read_b64_tr_b16 v[62:63], v21 offset:4096
  ds_read_b64_tr_b16 v[64:65], v22 offset:4096
  ds_read_b64_tr_b16 v[66:67], v23 offset:4096
  ds_read_b64_tr_b16 v[68:69], v24 offset:4096
  ds_read_b64_tr_b16 v[70:71], v25 offset:4096
  ds_read_b64_tr_b16 v[72:73], v26 offset:4096
  ds_read_b64_tr_b16 v[74:75], v27 offset:4096
  s_waitcnt lgkmcnt(0)
  v_mfma_f32_16x16x16_bf16 v[100:103], v[60:61], v[80:81], v[100:103]
  v_mfma_f32_16x16x16_bf16 v[104:107], v[62:63], v[80:81], v[104:107]
  v_mfma_f32_16x16x16_bf16 v[108:111], v[64:65], v[80:81], v[108:111]
  v_mfma_f32_16x16x16_bf16 v[112:115], v[66:67], v[80:81], v[112:115]
  v_mfma_f32_16x16x16_bf16 v[116:119], v[68:69], v[80:81], v[116:119]
  v_mfma_f32_16x16x16_bf16 v[120:123], v[70:71], v[80:81], v[120:123]
  v_mfma_f32_16x16x16_bf16 v[124:127], v[72:73], v[80:81], v[124:127]
  v_mfma_f32_16x16x16_bf16 v[128:131], v[74:75], v[80:81], v[128:131]
  s_mov_b32 m0, s43
  s_nop 0
  buffer_load_dwordx4 v14, s[8:11], s41 offen offset:0 nt lds
  buffer_load_dwordx4 v15, s[8:11], s41 offen offset:1024 nt lds
  buffer_load_dwordx4 v14, s[8:11], s41 offen offset:2048 nt lds
  buffer_load_dwordx4 v15, s[8:11], s41 offen offset:3072 nt lds
  s_add_u32 s41, s41, 0x4000
  s_waitcnt vmcnt(13)
  ds_read_b128 v[44:47], v16 offset:8192
  ds_read_b128 v[48:51], v17 offset:8192
  ds_read_b128 v[52:55], v18 offset:8192
  ds_read_b128 v[56:59], v19 offset:8192
  s_waitcnt lgkmcnt(0)
  v_mfma_f32_16x16x32_bf16 v[76:79], v[44:47], v[28:31], 0
  v_mfma_f32_16x16x32_bf16 v[76:79], v[48:51], v[32:35], v[76:79]
  v_mfma_f32_16x16x32_bf16 v[76:79], v[52:55], v[36:39], v[76:79]
  v_mfma_f32_16x16x32_bf16 v[76:79], v[56:59], v[40:43], v[76:79]
  s_mov_b32 m0, s44
  s_nop 0
  buffer_load_dwordx4 v10, s[4:7], s40 offen offset:0 nt lds
  buffer_load_dwordx4 v11, s[4:7], s40 offen offset:1024 nt lds
  buffer_load_dwordx4 v12, s[4:7], s40 offen offset:2048 nt lds
  buffer_load_dwordx4 v13, s[4:7], s40 offen offset:3072 nt lds
  v_mov_b32 v133, 1
  s_mov_b64 exec, 1
  buffer_atomic_add v133, off, s[12:15], s90 sc0 sc1
  s_mov_b64 exec, -1
  s_add_u32 s40, s40, 0x4000
  v_cvt_pk_bf16_f32 v86, v76, v77
  v_cvt_pk_bf16_f32 v87, v78, v79
  v_lshlrev_b32 v76, 16, v86
  v_and_b32 v77, 0xffff0000, v86
  v_lshlrev_b32 v78, 16, v87
  v_and_b32 v79, 0xffff0000, v87
  v_mul_f32 v76, 0x3db504f3, v76
  v_mul_f32 v77, 0x3db504f3, v77
  v_mul_f32 v78, 0x3db504f3, v78
  v_mul_f32 v79, 0x3db504f3, v79
  v_cvt_pk_bf16_f32 v86, v76, v77
  v_cvt_pk_bf16_f32 v87, v78, v79
  v_lshlrev_b32 v76, 16, v86
  v_and_b32 v77, 0xffff0000, v86
  v_lshlrev_b32 v78, 16, v87
  v_and_b32 v79, 0xffff0000, v87
  v_max3_f32 v88, v76, v77, v78
  v_max3_f32 v88, v88, v79, v82
  v_mov_b32 v89, v88
  s_nop 1
  v_permlane16_swap_b32 v88, v89
  v_max_f32 v88, v88, v89
  v_mov_b32 v89, v88
  s_nop 1
  v_permlane32_swap_b32 v88, v89
  v_max_f32 v88, v88, v89
  v_mul_f32 v89, 0x3fb8aa3b, v88
  v_cmp_gt_f32 vcc, v88, v82
  v_fma_f32 v76, v76, s47, -v89
  v_fma_f32 v77, v77, s47, -v89
  v_fma_f32 v78, v78, s47, -v89
  v_fma_f32 v79, v79, s47, -v89
  v_exp_f32 v76, v76
  v_exp_f32 v77, v77
  v_exp_f32 v78, v78
  v_exp_f32 v79, v79
  s_cbranch_vccz noresc_809
  v_sub_f32 v90, v83, v89
  v_exp_f32 v90, v90
  v_mov_b32 v82, v88
  v_mov_b32 v83, v89
  v_mul_f32 v84, v84, v90
  v_mul_f32 v100, v100, v90
  v_mul_f32 v101, v101, v90
  v_mul_f32 v102, v102, v90
  v_mul_f32 v103, v103, v90
  v_mul_f32 v104, v104, v90
  v_mul_f32 v105, v105, v90
  v_mul_f32 v106, v106, v90
  v_mul_f32 v107, v107, v90
  v_mul_f32 v108, v108, v90
  v_mul_f32 v109, v109, v90
  v_mul_f32 v110, v110, v90
  v_mul_f32 v111, v111, v90
  v_mul_f32 v112, v112, v90
  v_mul_f32 v113, v113, v90
  v_mul_f32 v114, v114, v90
  v_mul_f32 v115, v115, v90
  v_mul_f32 v116, v116, v90
  v_mul_f32 v117, v117, v90
  v_mul_f32 v118, v118, v90
  v_mul_f32 v119, v119, v90
  v_mul_f32 v120, v120, v90
  v_mul_f32 v121, v121, v90
  v_mul_f32 v122, v122, v90
  v_mul_f32 v123, v123, v90
  v_mul_f32 v124, v124, v90
  v_mul_f32 v125, v125, v90
  v_mul_f32 v126, v126, v90
  v_mul_f32 v127, v127, v90
  v_mul_f32 v128, v128, v90
  v_mul_f32 v129, v129, v90
  v_mul_f32 v130, v130, v90
  v_mul_f32 v131, v131, v90
noresc_809:
  v_add_f32 v91, v76, v77
  v_add_f32 v92, v78, v79
  v_cvt_pk_bf16_f32 v86, v76, v77
  v_cvt_pk_bf16_f32 v87, v78, v79
  v_add_f32 v91, v91, v92
  v_lshlrev_b32 v93, 16, v86
  v_and_b32 v94, 0xffff0000, v86
  v_lshlrev_b32 v95, 16, v87
  v_and_b32 v96, 0xffff0000, v87
  v_add_f32 v84, v84, v91
  v_fma_f32 v76, v93, v85, v76
  v_fma_f32 v77, v94, v85, v77
  v_fma_f32 v78, v95, v85, v78
  v_fma_f32 v79, v96, v85, v79
  v_cvt_pk_bf16_f32 v80, v76, v77
  v_cvt_pk_bf16_f32 v81, v78, v79
  s_waitcnt vmcnt(14)
  ds_read_b64_tr_b16 v[60:61], v20 offset:12288
  ds_read_b64_tr_b16 v[62:63], v21 offset:12288
  ds_read_b64_tr_b16 v[64:65], v22 offset:12288
  ds_read_b64_tr_b16 v[66:67], v23 offset:12288
  ds_read_b64_tr_b16 v[68:69], v24 offset:12288
  ds_read_b64_tr_b16 v[70:71], v25 offset:12288
  ds_read_b64_tr_b16 v[72:73], v26 offset:12288
  ds_read_b64_tr_b16 v[74:75], v27 offset:12288
  s_waitcnt lgkmcnt(0)
  v_mfma_f32_16x16x16_bf16 v[100:103], v[60:61], v[80:81], v[100:103]
  v_mfma_f32_16x16x16_bf16 v[104:107], v[62:63], v[80:81], v[104:107]
  v_mfma_f32_16x16x16_bf16 v[108:111], v[64:65], v[80:81], v[108:111]
  v_mfma_f32_16x16x16_bf16 v[112:115], v[66:67], v[80:81], v[112:115]
  v_mfma_f32_16x16x16_bf16 v[116:119], v[68:69], v[80:81], v[116:119]
  v_mfma_f32_16x16x16_bf16 v[120:123], v[70:71], v[80:81], v[120:123]
  v_mfma_f32_16x16x16_bf16 v[124:127], v[72:73], v[80:81], v[124:127]
  v_mfma_f32_16x16x16_bf16 v[128:131], v[74:75], v[80:81], v[128:131]
  s_mov_b32 m0, s45
  s_nop 0
  buffer_load_dwordx4 v14, s[8:11], s41 offen offset:0 nt lds
  buffer_load_dwordx4 v15, s[8:11], s41 offen offset:1024 nt lds
  buffer_load_dwordx4 v14, s[8:11], s41 offen offset:2048 nt lds
  buffer_load_dwordx4 v15, s[8:11], s41 offen offset:3072 nt lds
  s_add_u32 s41, s41, 0x4000
dynloop_810:
  s_waitcnt vmcnt(13)
  v_readfirstlane_b32 s92, v132
  s_cmp_ge_u32 s92, 64
  s_cbranch_scc1 L_drain0
  s_lshl_b32 s92, s92, 14
  s_add_u32 s40, s91, s92
  s_mov_b32 s41, s40
  ds_read_b128 v[44:47], v16 offset:0
  ds_read_b128 v[48:51], v17 offset:0
  ds_read_b128 v[52:55], v18 offset:0
  ds_read_b128 v[56:59], v19 offset:0
  s_waitcnt lgkmcnt(0)
  v_mfma_f32_16x16x32_bf16 v[76:79], v[44:47], v[28:31], 0
  v_mfma_f32_16x16x32_bf16 v[76:79], v[48:51], v[32:35], v[76:79]
  v_mfma_f32_16x16x32_bf16 v[76:79], v[52:55], v[36:39], v[76:79]
  v_mfma_f32_16x16x32_bf16 v[76:79], v[56:59], v[40:43], v[76:79]
  s_mov_b32 m0, s42
  s_nop 0
  buffer_load_dwordx4 v10, s[4:7], s40 offen offset:0 nt lds
  buffer_load_dwordx4 v11, s[4:7], s40 offen offset:1024 nt lds
  buffer_load_dwordx4 v12, s[4:7], s40 offen offset:2048 nt lds
  buffer_load_dwordx4 v13, s[4:7], s40 offen offset:3072 nt lds
  v_mov_b32 v132, 1
  s_mov_b64 exec, 1
  buffer_atomic_add v132, off, s[12:15], s90 sc0 sc1
  s_mov_b64 exec, -1
  v_cvt_pk_bf16_f32 v86, v76, v77
  v_cvt_pk_bf16_f32 v87, v78, v79
  v_lshlrev_b32 v76, 16, v86
  v_and_b32 v77, 0xffff0000, v86
  v_lshlrev_b32 v78, 16, v87
  v_and_b32 v79, 0xffff0000, v87
  v_mul_f32 v76, 0x3db504f3, v76
  v_mul_f32 v77, 0x3db504f3, v77
  v_mul_f32 v78, 0x3db504f3, v78
  v_mul_f32 v79, 0x3db504f3, v79
  v_cvt_pk_bf16_f32 v86, v76, v77
  v_cvt_pk_bf16_f32 v87, v78, v79
  v_lshlrev_b32 v76, 16, v86
  v_and_b32 v77, 0xffff0000, v86
  v_lshlrev_b32 v78, 16, v87
  v_and_b32 v79, 0xffff0000, v87
  v_max3_f32 v88, v76, v77, v78
  v_max3_f32 v88, v88, v79, v82
  v_mov_b32 v89, v88
  s_nop 1
  v_permlane16_swap_b32 v88, v89
  v_max_f32 v88, v88, v89
  v_mov_b32 v89, v88
  s_nop 1
  v_permlane32_swap_b32 v88, v89
  v_max_f32 v88, v88, v89
  v_mul_f32 v89, 0x3fb8aa3b, v88
  v_cmp_gt_f32 vcc, v88, v82
  v_fma_f32 v76, v76, s47, -v89
  v_fma_f32 v77, v77, s47, -v89
  v_fma_f32 v78, v78, s47, -v89
  v_fma_f32 v79, v79, s47, -v89
  v_exp_f32 v76, v76
  v_exp_f32 v77, v77
  v_exp_f32 v78, v78
  v_exp_f32 v79, v79
  s_cbranch_vccz noresc_911
  v_sub_f32 v90, v83, v89
  v_exp_f32 v90, v90
  v_mov_b32 v82, v88
  v_mov_b32 v83, v89
  v_mul_f32 v84, v84, v90
  v_mul_f32 v100, v100, v90
  v_mul_f32 v101, v101, v90
  v_mul_f32 v102, v102, v90
  v_mul_f32 v103, v103, v90
  v_mul_f32 v104, v104, v90
  v_mul_f32 v105, v105, v90
  v_mul_f32 v106, v106, v90
  v_mul_f32 v107, v107, v90
  v_mul_f32 v108, v108, v90
  v_mul_f32 v109, v109, v90
  v_mul_f32 v110, v110, v90
  v_mul_f32 v111, v111, v90
  v_mul_f32 v112, v112, v90
  v_mul_f32 v113, v113, v90
  v_mul_f32 v114, v114, v90
  v_mul_f32 v115, v115, v90
  v_mul_f32 v116, v116, v90
  v_mul_f32 v117, v117, v90
  v_mul_f32 v118, v118, v90
  v_mul_f32 v119, v119, v90
  v_mul_f32 v120, v120, v90
  v_mul_f32 v121, v121, v90
  v_mul_f32 v122, v122, v90
  v_mul_f32 v123, v123, v90
  v_mul_f32 v124, v124, v90
  v_mul_f32 v125, v125, v90
  v_mul_f32 v126, v126, v90
  v_mul_f32 v127, v127, v90
  v_mul_f32 v128, v128, v90
  v_mul_f32 v129, v129, v90
  v_mul_f32 v130, v130, v90
  v_mul_f32 v131, v131, v90
noresc_911:
  v_add_f32 v91, v76, v77
  v_add_f32 v92, v78, v79
  v_cvt_pk_bf16_f32 v86, v76, v77
  v_cvt_pk_bf16_f32 v87, v78, v79
  v_add_f32 v91, v91, v92
  v_lshlrev_b32 v93, 16, v86
  v_and_b32 v94, 0xffff0000, v86
  v_lshlrev_b32 v95, 16, v87
  v_and_b32 v96, 0xffff0000, v87
  v_add_f32 v84, v84, v91
  v_fma_f32 v76, v93, v85, v76
  v_fma_f32 v77, v94, v85, v77
  v_fma_f32 v78, v95, v85, v78
  v_fma_f32 v79, v96, v85, v79
  v_cvt_pk_bf16_f32 v80, v76, v77
  v_cvt_pk_bf16_f32 v81, v78, v79
  s_waitcnt vmcnt(14)
  ds_read_b64_tr_b16 v[60:61], v20 offset:4096
  ds_read_b64_tr_b16 v[62:63], v21 offset:4096
  ds_read_b64_tr_b16 v[64:65], v22 offset:4096
  ds_read_b64_tr_b16 v[66:67], v23 offset:4096
  ds_read_b64_tr_b16 v[68:69], v24 offset:4096
  ds_read_b64_tr_b16 v[70:71], v25 offset:4096
  ds_read_b64_tr_b16 v[72:73], v26 offset:4096
  ds_read_b64_tr_b16 v[74:75], v27 offset:4096
  s_waitcnt lgkmcnt(0)
  v_mfma_f32_16x16x16_bf16 v[100:103], v[60:61], v[80:81], v[100:103]
  v_mfma_f32_16x16x16_bf16 v[104:107], v[62:63], v[80:81], v[104:107]
  v_mfma_f32_16x16x16_bf16 v[108:111], v[64:65], v[80:81], v[108:111]
  v_mfma_f32_16x16x16_bf16 v[112:115], v[66:67], v[80:81], v[112:115]
  v_mfma_f32_16x16x16_bf16 v[116:119], v[68:69], v[80:81], v[116:119]
  v_mfma_f32_16x16x16_bf16 v[120:123], v[70:71], v[80:81], v[120:123]
  v_mfma_f32_16x16x16_bf16 v[124:127], v[72:73], v[80:81], v[124:127]
  v_mfma_f32_16x16x16_bf16 v[128:131], v[74:75], v[80:81], v[128:131]
  s_mov_b32 m0, s43
  s_nop 0
  buffer_load_dwordx4 v14, s[8:11], s41 offen offset:0 nt lds
  buffer_load_dwordx4 v15, s[8:11], s41 offen offset:1024 nt lds
  buffer_load_dwordx4 v14, s[8:11], s41 offen offset:2048 nt lds
  buffer_load_dwordx4 v15, s[8:11], s41 offen offset:3072 nt lds
  s_waitcnt vmcnt(13)
  v_readfirstlane_b32 s92, v133
  s_cmp_ge_u32 s92, 64
  s_cbranch_scc1 L_drain1
  s_lshl_b32 s92, s92, 14
  s_add_u32 s40, s91, s92
  s_mov_b32 s41, s40
  ds_read_b128 v[44:47], v16 offset:8192
  ds_read_b128 v[48:51], v17 offset:8192
  ds_read_b128 v[52:55], v18 offset:8192
  ds_read_b128 v[56:59], v19 offset:8192
  s_waitcnt lgkmcnt(0)
  v_mfma_f32_16x16x32_bf16 v[76:79], v[44:47], v[28:31], 0
  v_mfma_f32_16x16x32_bf16 v[76:79], v[48:51], v[32:35], v[76:79]
  v_mfma_f32_16x16x32_bf16 v[76:79], v[52:55], v[36:39], v[76:79]
  v_mfma_f32_16x16x32_bf16 v[76:79], v[56:59], v[40:43], v[76:79]
  s_mov_b32 m0, s44
  s_nop 0
  buffer_load_dwordx4 v10, s[4:7], s40 offen offset:0 nt lds
  buffer_load_dwordx4 v11, s[4:7], s40 offen offset:1024 nt lds
  buffer_load_dwordx4 v12, s[4:7], s40 offen offset:2048 nt lds
  buffer_load_dwordx4 v13, s[4:7], s40 offen offset:3072 nt lds
  v_mov_b32 v133, 1
  s_mov_b64 exec, 1
  buffer_atomic_add v133, off, s[12:15], s90 sc0 sc1
  s_mov_b64 exec, -1
  v_cvt_pk_bf16_f32 v86, v76, v77
  v_cvt_pk_bf16_f32 v87, v78, v79
  v_lshlrev_b32 v76, 16, v86
  v_and_b32 v77, 0xffff0000, v86
  v_lshlrev_b32 v78, 16, v87
  v_and_b32 v79, 0xffff0000, v87
  v_mul_f32 v76, 0x3db504f3, v76
  v_mul_f32 v77, 0x3db504f3, v77
  v_mul_f32 v78, 0x3db504f3, v78
  v_mul_f32 v79, 0x3db504f3, v79
  v_cvt_pk_bf16_f32 v86, v76, v77
  v_cvt_pk_bf16_f32 v87, v78, v79
  v_lshlrev_b32 v76, 16, v86
  v_and_b32 v77, 0xffff0000, v86
  v_lshlrev_b32 v78, 16, v87
  v_and_b32 v79, 0xffff0000, v87
  v_max3_f32 v88, v76, v77, v78
  v_max3_f32 v88, v88, v79, v82
  v_mov_b32 v89, v88
  s_nop 1
  v_permlane16_swap_b32 v88, v89
  v_max_f32 v88, v88, v89
  v_mov_b32 v89, v88
  s_nop 1
  v_permlane32_swap_b32 v88, v89
  v_max_f32 v88, v88, v89
  v_mul_f32 v89, 0x3fb8aa3b, v88
  v_cmp_gt_f32 vcc, v88, v82
  v_fma_f32 v76, v76, s47, -v89
  v_fma_f32 v77, v77, s47, -v89
  v_fma_f32 v78, v78, s47, -v89
  v_fma_f32 v79, v79, s47, -v89
  v_exp_f32 v76, v76
  v_exp_f32 v77, v77
  v_exp_f32 v78, v78
  v_exp_f32 v79, v79
  s_cbranch_vccz noresc_1012
  v_sub_f32 v90, v83, v89
  v_exp_f32 v90, v90
  v_mov_b32 v82, v88
  v_mov_b32 v83, v89
  v_mul_f32 v84, v84, v90
  v_mul_f32 v100, v100, v90
  v_mul_f32 v101, v101, v90
  v_mul_f32 v102, v102, v90
  v_mul_f32 v103, v103, v90
  v_mul_f32 v104, v104, v90
  v_mul_f32 v105, v105, v90
  v_mul_f32 v106, v106, v90
  v_mul_f32 v107, v107, v90
  v_mul_f32 v108, v108, v90
  v_mul_f32 v109, v109, v90
  v_mul_f32 v110, v110, v90
  v_mul_f32 v111, v111, v90
  v_mul_f32 v112, v112, v90
  v_mul_f32 v113, v113, v90
  v_mul_f32 v114, v114, v90
  v_mul_f32 v115, v115, v90
  v_mul_f32 v116, v116, v90
  v_mul_f32 v117, v117, v90
  v_mul_f32 v118, v118, v90
  v_mul_f32 v119, v119, v90
  v_mul_f32 v120, v120, v90
  v_mul_f32 v121, v121, v90
  v_mul_f32 v122, v122, v90
  v_mul_f32 v123, v123, v90
  v_mul_f32 v124, v124, v90
  v_mul_f32 v125, v125, v90
  v_mul_f32 v126, v126, v90
  v_mul_f32 v127, v127, v90
  v_mul_f32 v128, v128, v90
  v_mul_f32 v129, v129, v90
  v_mul_f32 v130, v130, v90
  v_mul_f32 v131, v131, v90
noresc_1012:
  v_add_f32 v91, v76, v77
  v_add_f32 v92, v78, v79
  v_cvt_pk_bf16_f32 v86, v76, v77
  v_cvt_pk_bf16_f32 v87, v78, v79
  v_add_f32 v91, v91, v92
  v_lshlrev_b32 v93, 16, v86
  v_and_b32 v94, 0xffff0000, v86
  v_lshlrev_b32 v95, 16, v87
  v_and_b32 v96, 0xffff0000, v87
  v_add_f32 v84, v84, v91
  v_fma_f32 v76, v93, v85, v76
  v_fma_f32 v77, v94, v85, v77
  v_fma_f32 v78, v95, v85, v78
  v_fma_f32 v79, v96, v85, v79
  v_cvt_pk_bf16_f32 v80, v76, v77
  v_cvt_pk_bf16_f32 v81, v78, v79
  s_waitcnt vmcnt(14)
  ds_read_b64_tr_b16 v[60:61], v20 offset:12288
  ds_read_b64_tr_b16 v[62:63], v21 offset:12288
  ds_read_b64_tr_b16 v[64:65], v22 offset:12288
  ds_read_b64_tr_b16 v[66:67], v23 offset:12288
  ds_read_b64_tr_b16 v[68:69], v24 offset:12288
  ds_read_b64_tr_b16 v[70:71], v25 offset:12288
  ds_read_b64_tr_b16 v[72:73], v26 offset:12288
  ds_read_b64_tr_b16 v[74:75], v27 offset:12288
  s_waitcnt lgkmcnt(0)
  v_mfma_f32_16x16x16_bf16 v[100:103], v[60:61], v[80:81], v[100:103]
  v_mfma_f32_16x16x16_bf16 v[104:107], v[62:63], v[80:81], v[104:107]
  v_mfma_f32_16x16x16_bf16 v[108:111], v[64:65], v[80:81], v[108:111]
  v_mfma_f32_16x16x16_bf16 v[112:115], v[66:67], v[80:81], v[112:115]
  v_mfma_f32_16x16x16_bf16 v[116:119], v[68:69], v[80:81], v[116:119]
  v_mfma_f32_16x16x16_bf16 v[120:123], v[70:71], v[80:81], v[120:123]
  v_mfma_f32_16x16x16_bf16 v[124:127], v[72:73], v[80:81], v[124:127]
  v_mfma_f32_16x16x16_bf16 v[128:131], v[74:75], v[80:81], v[128:131]
  s_mov_b32 m0, s45
  s_nop 0
  buffer_load_dwordx4 v14, s[8:11], s41 offen offset:0 nt lds
  buffer_load_dwordx4 v15, s[8:11], s41 offen offset:1024 nt lds
  buffer_load_dwordx4 v14, s[8:11], s41 offen offset:2048 nt lds
  buffer_load_dwordx4 v15, s[8:11], s41 offen offset:3072 nt lds
  s_branch dynloop_810
L_drain0:
  ds_read_b128 v[44:47], v16 offset:0
  ds_read_b128 v[48:51], v17 offset:0
  ds_read_b128 v[52:55], v18 offset:0
  ds_read_b128 v[56:59], v19 offset:0
  s_waitcnt lgkmcnt(0)
  v_mfma_f32_16x16x32_bf16 v[76:79], v[44:47], v[28:31], 0
  v_mfma_f32_16x16x32_bf16 v[76:79], v[48:51], v[32:35], v[76:79]
  v_mfma_f32_16x16x32_bf16 v[76:79], v[52:55], v[36:39], v[76:79]
  v_mfma_f32_16x16x32_bf16 v[76:79], v[56:59], v[40:43], v[76:79]
  s_nop 7
  v_cvt_pk_bf16_f32 v86, v76, v77
  v_cvt_pk_bf16_f32 v87, v78, v79
  v_lshlrev_b32 v76, 16, v86
  v_and_b32 v77, 0xffff0000, v86
  v_lshlrev_b32 v78, 16, v87
  v_and_b32 v79, 0xffff0000, v87
  v_mul_f32 v76, 0x3db504f3, v76
  v_mul_f32 v77, 0x3db504f3, v77
  v_mul_f32 v78, 0x3db504f3, v78
  v_mul_f32 v79, 0x3db504f3, v79
  v_cvt_pk_bf16_f32 v86, v76, v77
  v_cvt_pk_bf16_f32 v87, v78, v79
  v_lshlrev_b32 v76, 16, v86
  v_and_b32 v77, 0xffff0000, v86
  v_lshlrev_b32 v78, 16, v87
  v_and_b32 v79, 0xffff0000, v87
  v_max3_f32 v88, v76, v77, v78
  v_max3_f32 v88, v88, v79, v82
  v_mov_b32 v89, v88
  s_nop 1
  v_permlane16_swap_b32 v88, v89
  v_max_f32 v88, v88, v89
  v_mov_b32 v89, v88
  s_nop 1
  v_permlane32_swap_b32 v88, v89
  v_max_f32 v88, v88, v89
  v_mul_f32 v89, 0x3fb8aa3b, v88
  v_cmp_gt_f32 vcc, v88, v82
  v_fma_f32 v76, v76, s47, -v89
  v_fma_f32 v77, v77, s47, -v89
  v_fma_f32 v78, v78, s47, -v89
  v_fma_f32 v79, v79, s47, -v89
  v_exp_f32 v76, v76
  v_exp_f32 v77, v77
  v_exp_f32 v78, v78
  v_exp_f32 v79, v79
  s_cbranch_vccz noresc_1113
  v_sub_f32 v90, v83, v89
  v_exp_f32 v90, v90
  v_mov_b32 v82, v88
  v_mov_b32 v83, v89
  v_mul_f32 v84, v84, v90
  v_mul_f32 v100, v100, v90
  v_mul_f32 v101, v101, v90
  v_mul_f32 v102, v102, v90
  v_mul_f32 v103, v103, v90
  v_mul_f32 v104, v104, v90
  v_mul_f32 v105, v105, v90
  v_mul_f32 v106, v106, v90
  v_mul_f32 v107, v107, v90
  v_mul_f32 v108, v108, v90
  v_mul_f32 v109, v109, v90
  v_mul_f32 v110, v110, v90
  v_mul_f32 v111, v111, v90
  v_mul_f32 v112, v112, v90
  v_mul_f32 v113, v113, v90
  v_mul_f32 v114, v114, v90
  v_mul_f32 v115, v115, v90
  v_mul_f32 v116, v116, v90
  v_mul_f32 v117, v117, v90
  v_mul_f32 v118, v118, v90
  v_mul_f32 v119, v119, v90
  v_mul_f32 v120, v120, v90
  v_mul_f32 v121, v121, v90
  v_mul_f32 v122, v122, v90
  v_mul_f32 v123, v123, v90
  v_mul_f32 v124, v124, v90
  v_mul_f32 v125, v125, v90
  v_mul_f32 v126, v126, v90
  v_mul_f32 v127, v127, v90
  v_mul_f32 v128, v128, v90
  v_mul_f32 v129, v129, v90
  v_mul_f32 v130, v130, v90
  v_mul_f32 v131, v131, v90
noresc_1113:
  v_add_f32 v91, v76, v77
  v_add_f32 v92, v78, v79
  v_cvt_pk_bf16_f32 v86, v76, v77
  v_cvt_pk_bf16_f32 v87, v78, v79
  v_add_f32 v91, v91, v92
  v_lshlrev_b32 v93, 16, v86
  v_and_b32 v94, 0xffff0000, v86
  v_lshlrev_b32 v95, 16, v87
  v_and_b32 v96, 0xffff0000, v87
  v_add_f32 v84, v84, v91
  v_fma_f32 v76, v93, v85, v76
  v_fma_f32 v77, v94, v85, v77
  v_fma_f32 v78, v95, v85, v78
  v_fma_f32 v79, v96, v85, v79
  v_cvt_pk_bf16_f32 v80, v76, v77
  v_cvt_pk_bf16_f32 v81, v78, v79
  s_waitcnt vmcnt(9)
  ds_read_b64_tr_b16 v[60:61], v20 offset:4096
  ds_read_b64_tr_b16 v[62:63], v21 offset:4096
  ds_read_b64_tr_b16 v[64:65], v22 offset:4096
  ds_read_b64_tr_b16 v[66:67], v23 offset:4096
  ds_read_b64_tr_b16 v[68:69], v24 offset:4096
  ds_read_b64_tr_b16 v[70:71], v25 offset:4096
  ds_read_b64_tr_b16 v[72:73], v26 offset:4096
  ds_read_b64_tr_b16 v[74:75], v27 offset:4096
  s_waitcnt lgkmcnt(0)
  v_mfma_f32_16x16x16_bf16 v[100:103], v[60:61], v[80:81], v[100:103]
  v_mfma_f32_16x16x16_bf16 v[104:107], v[62:63], v[80:81], v[104:107]
  v_mfma_f32_16x16x16_bf16 v[108:111], v[64:65], v[80:81], v[108:111]
  v_mfma_f32_16x16x16_bf16 v[112:115], v[66:67], v[80:81], v[112:115]
  v_mfma_f32_16x16x16_bf16 v[116:119], v[68:69], v[80:81], v[116:119]
  v_mfma_f32_16x16x16_bf16 v[120:123], v[70:71], v[80:81], v[120:123]
  v_mfma_f32_16x16x16_bf16 v[124:127], v[72:73], v[80:81], v[124:127]
  v_mfma_f32_16x16x16_bf16 v[128:131], v[74:75], v[80:81], v[128:131]
  s_waitcnt vmcnt(5)
  ds_read_b128 v[44:47], v16 offset:8192
  ds_read_b128 v[48:51], v17 offset:8192
  ds_read_b128 v[52:55], v18 offset:8192
  ds_read_b128 v[56:59], v19 offset:8192
  s_waitcnt lgkmcnt(0)
  v_mfma_f32_16x16x32_bf16 v[76:79], v[44:47], v[28:31], 0
  v_mfma_f32_16x16x32_bf16 v[76:79], v[48:51], v[32:35], v[76:79]
  v_mfma_f32_16x16x32_bf16 v[76:79], v[52:55], v[36:39], v[76:79]
  v_mfma_f32_16x16x32_bf16 v[76:79], v[56:59], v[40:43], v[76:79]
  s_nop 7
  v_cvt_pk_bf16_f32 v86, v76, v77
  v_cvt_pk_bf16_f32 v87, v78, v79
  v_lshlrev_b32 v76, 16, v86
  v_and_b32 v77, 0xffff0000, v86
  v_lshlrev_b32 v78, 16, v87
  v_and_b32 v79, 0xffff0000, v87
  v_mul_f32 v76, 0x3db504f3, v76
  v_mul_f32 v77, 0x3db504f3, v77
  v_mul_f32 v78, 0x3db504f3, v78
  v_mul_f32 v79, 0x3db504f3, v79
  v_cvt_pk_bf16_f32 v86, v76, v77
  v_cvt_pk_bf16_f32 v87, v78, v79
  v_lshlrev_b32 v76, 16, v86
  v_and_b32 v77, 0xffff0000, v86
  v_lshlrev_b32 v78, 16, v87
  v_and_b32 v79, 0xffff0000, v87
  v_max3_f32 v88, v76, v77, v78
  v_max3_f32 v88, v88, v79, v82
  v_mov_b32 v89, v88
  s_nop 1
  v_permlane16_swap_b32 v88, v89
  v_max_f32 v88, v88, v89
  v_mov_b32 v89, v88
  s_nop 1
  v_permlane32_swap_b32 v88, v89
  v_max_f32 v88, v88, v89
  v_mul_f32 v89, 0x3fb8aa3b, v88
  v_cmp_gt_f32 vcc, v88, v82
  v_fma_f32 v76, v76, s47, -v89
  v_fma_f32 v77, v77, s47, -v89
  v_fma_f32 v78, v78, s47, -v89
  v_fma_f32 v79, v79, s47, -v89
  v_exp_f32 v76, v76
  v_exp_f32 v77, v77
  v_exp_f32 v78, v78
  v_exp_f32 v79, v79
  s_cbranch_vccz noresc_1214
  v_sub_f32 v90, v83, v89
  v_exp_f32 v90, v90
  v_mov_b32 v82, v88
  v_mov_b32 v83, v89
  v_mul_f32 v84, v84, v90
  v_mul_f32 v100, v100, v90
  v_mul_f32 v101, v101, v90
  v_mul_f32 v102, v102, v90
  v_mul_f32 v103, v103, v90
  v_mul_f32 v104, v104, v90
  v_mul_f32 v105, v105, v90
  v_mul_f32 v106, v106, v90
  v_mul_f32 v107, v107, v90
  v_mul_f32 v108, v108, v90
  v_mul_f32 v109, v109, v90
  v_mul_f32 v110, v110, v90
  v_mul_f32 v111, v111, v90
  v_mul_f32 v112, v112, v90
  v_mul_f32 v113, v113, v90
  v_mul_f32 v114, v114, v90
  v_mul_f32 v115, v115, v90
  v_mul_f32 v116, v116, v90
  v_mul_f32 v117, v117, v90
  v_mul_f32 v118, v118, v90
  v_mul_f32 v119, v119, v90
  v_mul_f32 v120, v120, v90
  v_mul_f32 v121, v121, v90
  v_mul_f32 v122, v122, v90
  v_mul_f32 v123, v123, v90
  v_mul_f32 v124, v124, v90
  v_mul_f32 v125, v125, v90
  v_mul_f32 v126, v126, v90
  v_mul_f32 v127, v127, v90
  v_mul_f32 v128, v128, v90
  v_mul_f32 v129, v129, v90
  v_mul_f32 v130, v130, v90
  v_mul_f32 v131, v131, v90
noresc_1214:
  v_add_f32 v91, v76, v77
  v_add_f32 v92, v78, v79
  v_cvt_pk_bf16_f32 v86, v76, v77
  v_cvt_pk_bf16_f32 v87, v78, v79
  v_add_f32 v91, v91, v92
  v_lshlrev_b32 v93, 16, v86
  v_and_b32 v94, 0xffff0000, v86
  v_lshlrev_b32 v95, 16, v87
  v_and_b32 v96, 0xffff0000, v87
  v_add_f32 v84, v84, v91
  v_fma_f32 v76, v93, v85, v76
  v_fma_f32 v77, v94, v85, v77
  v_fma_f32 v78, v95, v85, v78
  v_fma_f32 v79, v96, v85, v79
  v_cvt_pk_bf16_f32 v80, v76, v77
  v_cvt_pk_bf16_f32 v81, v78, v79
  s_waitcnt vmcnt(0)
  ds_read_b64_tr_b16 v[60:61], v20 offset:12288
  ds_read_b64_tr_b16 v[62:63], v21 offset:12288
  ds_read_b64_tr_b16 v[64:65], v22 offset:12288
  ds_read_b64_tr_b16 v[66:67], v23 offset:12288
  ds_read_b64_tr_b16 v[68:69], v24 offset:12288
  ds_read_b64_tr_b16 v[70:71], v25 offset:12288
  ds_read_b64_tr_b16 v[72:73], v26 offset:12288
  ds_read_b64_tr_b16 v[74:75], v27 offset:12288
  s_waitcnt lgkmcnt(0)
  v_mfma_f32_16x16x16_bf16 v[100:103], v[60:61], v[80:81], v[100:103]
  v_mfma_f32_16x16x16_bf16 v[104:107], v[62:63], v[80:81], v[104:107]
  v_mfma_f32_16x16x16_bf16 v[108:111], v[64:65], v[80:81], v[108:111]
  v_mfma_f32_16x16x16_bf16 v[112:115], v[66:67], v[80:81], v[112:115]
  v_mfma_f32_16x16x16_bf16 v[116:119], v[68:69], v[80:81], v[116:119]
  v_mfma_f32_16x16x16_bf16 v[120:123], v[70:71], v[80:81], v[120:123]
  v_mfma_f32_16x16x16_bf16 v[124:127], v[72:73], v[80:81], v[124:127]
  v_mfma_f32_16x16x16_bf16 v[128:131], v[74:75], v[80:81], v[128:131]
  s_branch L_attdone
L_drain1:
  ds_read_b128 v[44:47], v16 offset:8192
  ds_read_b128 v[48:51], v17 offset:8192
  ds_read_b128 v[52:55], v18 offset:8192
  ds_read_b128 v[56:59], v19 offset:8192
  s_waitcnt lgkmcnt(0)
  v_mfma_f32_16x16x32_bf16 v[76:79], v[44:47], v[28:31], 0
  v_mfma_f32_16x16x32_bf16 v[76:79], v[48:51], v[32:35], v[76:79]
  v_mfma_f32_16x16x32_bf16 v[76:79], v[52:55], v[36:39], v[76:79]
  v_mfma_f32_16x16x32_bf16 v[76:79], v[56:59], v[40:43], v[76:79]
  s_nop 7
  v_cvt_pk_bf16_f32 v86, v76, v77
  v_cvt_pk_bf16_f32 v87, v78, v79
  v_lshlrev_b32 v76, 16, v86
  v_and_b32 v77, 0xffff0000, v86
  v_lshlrev_b32 v78, 16, v87
  v_and_b32 v79, 0xffff0000, v87
  v_mul_f32 v76, 0x3db504f3, v76
  v_mul_f32 v77, 0x3db504f3, v77
  v_mul_f32 v78, 0x3db504f3, v78
  v_mul_f32 v79, 0x3db504f3, v79
  v_cvt_pk_bf16_f32 v86, v76, v77
  v_cvt_pk_bf16_f32 v87, v78, v79
  v_lshlrev_b32 v76, 16, v86
  v_and_b32 v77, 0xffff0000, v86
  v_lshlrev_b32 v78, 16, v87
  v_and_b32 v79, 0xffff0000, v87
  v_max3_f32 v88, v76, v77, v78
  v_max3_f32 v88, v88, v79, v82
  v_mov_b32 v89, v88
  s_nop 1
  v_permlane16_swap_b32 v88, v89
  v_max_f32 v88, v88, v89
  v_mov_b32 v89, v88
  s_nop 1
  v_permlane32_swap_b32 v88, v89
  v_max_f32 v88, v88, v89
  v_mul_f32 v89, 0x3fb8aa3b, v88
  v_cmp_gt_f32 vcc, v88, v82
  v_fma_f32 v76, v76, s47, -v89
  v_fma_f32 v77, v77, s47, -v89
  v_fma_f32 v78, v78, s47, -v89
  v_fma_f32 v79, v79, s47, -v89
  v_exp_f32 v76, v76
  v_exp_f32 v77, v77
  v_exp_f32 v78, v78
  v_exp_f32 v79, v79
  s_cbranch_vccz noresc_1315
  v_sub_f32 v90, v83, v89
  v_exp_f32 v90, v90
  v_mov_b32 v82, v88
  v_mov_b32 v83, v89
  v_mul_f32 v84, v84, v90
  v_mul_f32 v100, v100, v90
  v_mul_f32 v101, v101, v90
  v_mul_f32 v102, v102, v90
  v_mul_f32 v103, v103, v90
  v_mul_f32 v104, v104, v90
  v_mul_f32 v105, v105, v90
  v_mul_f32 v106, v106, v90
  v_mul_f32 v107, v107, v90
  v_mul_f32 v108, v108, v90
  v_mul_f32 v109, v109, v90
  v_mul_f32 v110, v110, v90
  v_mul_f32 v111, v111, v90
  v_mul_f32 v112, v112, v90
  v_mul_f32 v113, v113, v90
  v_mul_f32 v114, v114, v90
  v_mul_f32 v115, v115, v90
  v_mul_f32 v116, v116, v90
  v_mul_f32 v117, v117, v90
  v_mul_f32 v118, v118, v90
  v_mul_f32 v119, v119, v90
  v_mul_f32 v120, v120, v90
  v_mul_f32 v121, v121, v90
  v_mul_f32 v122, v122, v90
  v_mul_f32 v123, v123, v90
  v_mul_f32 v124, v124, v90
  v_mul_f32 v125, v125, v90
  v_mul_f32 v126, v126, v90
  v_mul_f32 v127, v127, v90
  v_mul_f32 v128, v128, v90
  v_mul_f32 v129, v129, v90
  v_mul_f32 v130, v130, v90
  v_mul_f32 v131, v131, v90
noresc_1315:
  v_add_f32 v91, v76, v77
  v_add_f32 v92, v78, v79
  v_cvt_pk_bf16_f32 v86, v76, v77
  v_cvt_pk_bf16_f32 v87, v78, v79
  v_add_f32 v91, v91, v92
  v_lshlrev_b32 v93, 16, v86
  v_and_b32 v94, 0xffff0000, v86
  v_lshlrev_b32 v95, 16, v87
  v_and_b32 v96, 0xffff0000, v87
  v_add_f32 v84, v84, v91
  v_fma_f32 v76, v93, v85, v76
  v_fma_f32 v77, v94, v85, v77
  v_fma_f32 v78, v95, v85, v78
  v_fma_f32 v79, v96, v85, v79
  v_cvt_pk_bf16_f32 v80, v76, v77
  v_cvt_pk_bf16_f32 v81, v78, v79
  s_waitcnt vmcnt(9)
  ds_read_b64_tr_b16 v[60:61], v20 offset:12288
  ds_read_b64_tr_b16 v[62:63], v21 offset:12288
  ds_read_b64_tr_b16 v[64:65], v22 offset:12288
  ds_read_b64_tr_b16 v[66:67], v23 offset:12288
  ds_read_b64_tr_b16 v[68:69], v24 offset:12288
  ds_read_b64_tr_b16 v[70:71], v25 offset:12288
  ds_read_b64_tr_b16 v[72:73], v26 offset:12288
  ds_read_b64_tr_b16 v[74:75], v27 offset:12288
  s_waitcnt lgkmcnt(0)
  v_mfma_f32_16x16x16_bf16 v[100:103], v[60:61], v[80:81], v[100:103]
  v_mfma_f32_16x16x16_bf16 v[104:107], v[62:63], v[80:81], v[104:107]
  v_mfma_f32_16x16x16_bf16 v[108:111], v[64:65], v[80:81], v[108:111]
  v_mfma_f32_16x16x16_bf16 v[112:115], v[66:67], v[80:81], v[112:115]
  v_mfma_f32_16x16x16_bf16 v[116:119], v[68:69], v[80:81], v[116:119]
  v_mfma_f32_16x16x16_bf16 v[120:123], v[70:71], v[80:81], v[120:123]
  v_mfma_f32_16x16x16_bf16 v[124:127], v[72:73], v[80:81], v[124:127]
  v_mfma_f32_16x16x16_bf16 v[128:131], v[74:75], v[80:81], v[128:131]
  s_waitcnt vmcnt(5)
  ds_read_b128 v[44:47], v16 offset:0
  ds_read_b128 v[48:51], v17 offset:0
  ds_read_b128 v[52:55], v18 offset:0
  ds_read_b128 v[56:59], v19 offset:0
  s_waitcnt lgkmcnt(0)
  v_mfma_f32_16x16x32_bf16 v[76:79], v[44:47], v[28:31], 0
  v_mfma_f32_16x16x32_bf16 v[76:79], v[48:51], v[32:35], v[76:79]
  v_mfma_f32_16x16x32_bf16 v[76:79], v[52:55], v[36:39], v[76:79]
  v_mfma_f32_16x16x32_bf16 v[76:79], v[56:59], v[40:43], v[76:79]
  s_nop 7
  v_cvt_pk_bf16_f32 v86, v76, v77
  v_cvt_pk_bf16_f32 v87, v78, v79
  v_lshlrev_b32 v76, 16, v86
  v_and_b32 v77, 0xffff0000, v86
  v_lshlrev_b32 v78, 16, v87
  v_and_b32 v79, 0xffff0000, v87
  v_mul_f32 v76, 0x3db504f3, v76
  v_mul_f32 v77, 0x3db504f3, v77
  v_mul_f32 v78, 0x3db504f3, v78
  v_mul_f32 v79, 0x3db504f3, v79
  v_cvt_pk_bf16_f32 v86, v76, v77
  v_cvt_pk_bf16_f32 v87, v78, v79
  v_lshlrev_b32 v76, 16, v86
  v_and_b32 v77, 0xffff0000, v86
  v_lshlrev_b32 v78, 16, v87
  v_and_b32 v79, 0xffff0000, v87
  v_max3_f32 v88, v76, v77, v78
  v_max3_f32 v88, v88, v79, v82
  v_mov_b32 v89, v88
  s_nop 1
  v_permlane16_swap_b32 v88, v89
  v_max_f32 v88, v88, v89
  v_mov_b32 v89, v88
  s_nop 1
  v_permlane32_swap_b32 v88, v89
  v_max_f32 v88, v88, v89
  v_mul_f32 v89, 0x3fb8aa3b, v88
  v_cmp_gt_f32 vcc, v88, v82
  v_fma_f32 v76, v76, s47, -v89
  v_fma_f32 v77, v77, s47, -v89
  v_fma_f32 v78, v78, s47, -v89
  v_fma_f32 v79, v79, s47, -v89
  v_exp_f32 v76, v76
  v_exp_f32 v77, v77
  v_exp_f32 v78, v78
  v_exp_f32 v79, v79
  s_cbranch_vccz noresc_1416
  v_sub_f32 v90, v83, v89
  v_exp_f32 v90, v90
  v_mov_b32 v82, v88
  v_mov_b32 v83, v89
  v_mul_f32 v84, v84, v90
  v_mul_f32 v100, v100, v90
  v_mul_f32 v101, v101, v90
  v_mul_f32 v102, v102, v90
  v_mul_f32 v103, v103, v90
  v_mul_f32 v104, v104, v90
  v_mul_f32 v105, v105, v90
  v_mul_f32 v106, v106, v90
  v_mul_f32 v107, v107, v90
  v_mul_f32 v108, v108, v90
  v_mul_f32 v109, v109, v90
  v_mul_f32 v110, v110, v90
  v_mul_f32 v111, v111, v90
  v_mul_f32 v112, v112, v90
  v_mul_f32 v113, v113, v90
  v_mul_f32 v114, v114, v90
  v_mul_f32 v115, v115, v90
  v_mul_f32 v116, v116, v90
  v_mul_f32 v117, v117, v90
  v_mul_f32 v118, v118, v90
  v_mul_f32 v119, v119, v90
  v_mul_f32 v120, v120, v90
  v_mul_f32 v121, v121, v90
  v_mul_f32 v122, v122, v90
  v_mul_f32 v123, v123, v90
  v_mul_f32 v124, v124, v90
  v_mul_f32 v125, v125, v90
  v_mul_f32 v126, v126, v90
  v_mul_f32 v127, v127, v90
  v_mul_f32 v128, v128, v90
  v_mul_f32 v129, v129, v90
  v_mul_f32 v130, v130, v90
  v_mul_f32 v131, v131, v90
noresc_1416:
  v_add_f32 v91, v76, v77
  v_add_f32 v92, v78, v79
  v_cvt_pk_bf16_f32 v86, v76, v77
  v_cvt_pk_bf16_f32 v87, v78, v79
  v_add_f32 v91, v91, v92
  v_lshlrev_b32 v93, 16, v86
  v_and_b32 v94, 0xffff0000, v86
  v_lshlrev_b32 v95, 16, v87
  v_and_b32 v96, 0xffff0000, v87
  v_add_f32 v84, v84, v91
  v_fma_f32 v76, v93, v85, v76
  v_fma_f32 v77, v94, v85, v77
  v_fma_f32 v78, v95, v85, v78
  v_fma_f32 v79, v96, v85, v79
  v_cvt_pk_bf16_f32 v80, v76, v77
  v_cvt_pk_bf16_f32 v81, v78, v79
  s_waitcnt vmcnt(0)
  ds_read_b64_tr_b16 v[60:61], v20 offset:4096
  ds_read_b64_tr_b16 v[62:63], v21 offset:4096
  ds_read_b64_tr_b16 v[64:65], v22 offset:4096
  ds_read_b64_tr_b16 v[66:67], v23 offset:4096
  ds_read_b64_tr_b16 v[68:69], v24 offset:4096
  ds_read_b64_tr_b16 v[70:71], v25 offset:4096
  ds_read_b64_tr_b16 v[72:73], v26 offset:4096
  ds_read_b64_tr_b16 v[74:75], v27 offset:4096
  s_waitcnt lgkmcnt(0)
  v_mfma_f32_16x16x16_bf16 v[100:103], v[60:61], v[80:81], v[100:103]
  v_mfma_f32_16x16x16_bf16 v[104:107], v[62:63], v[80:81], v[104:107]
  v_mfma_f32_16x16x16_bf16 v[108:111], v[64:65], v[80:81], v[108:111]
  v_mfma_f32_16x16x16_bf16 v[112:115], v[66:67], v[80:81], v[112:115]
  v_mfma_f32_16x16x16_bf16 v[116:119], v[68:69], v[80:81], v[116:119]
  v_mfma_f32_16x16x16_bf16 v[120:123], v[70:71], v[80:81], v[120:123]
  v_mfma_f32_16x16x16_bf16 v[124:127], v[72:73], v[80:81], v[124:127]
  v_mfma_f32_16x16x16_bf16 v[128:131], v[74:75], v[80:81], v[128:131]
L_attdone:
  v_mov_b32 v86, v84
  s_nop 1
  v_permlane16_swap_b32 v84, v86
  v_add_f32 v84, v84, v86
  v_mov_b32 v86, v84
  s_nop 1
  v_permlane32_swap_b32 v84, v86
  v_add_f32 v84, v84, v86
  v_add_f32_dpp v100, v100, v100 row_ror:4 row_mask:0xf bank_mask:0xf
  v_add_f32_dpp v101, v101, v101 row_ror:4 row_mask:0xf bank_mask:0xf
  v_add_f32_dpp v102, v102, v102 row_ror:4 row_mask:0xf bank_mask:0xf
  v_add_f32_dpp v103, v103, v103 row_ror:4 row_mask:0xf bank_mask:0xf
  v_add_f32_dpp v104, v104, v104 row_ror:4 row_mask:0xf bank_mask:0xf
  v_add_f32_dpp v105, v105, v105 row_ror:4 row_mask:0xf bank_mask:0xf
  v_add_f32_dpp v106, v106, v106 row_ror:4 row_mask:0xf bank_mask:0xf
  v_add_f32_dpp v107, v107, v107 row_ror:4 row_mask:0xf bank_mask:0xf
  v_add_f32_dpp v108, v108, v108 row_ror:4 row_mask:0xf bank_mask:0xf
  v_add_f32_dpp v109, v109, v109 row_ror:4 row_mask:0xf bank_mask:0xf
  v_add_f32_dpp v110, v110, v110 row_ror:4 row_mask:0xf bank_mask:0xf
  v_add_f32_dpp v111, v111, v111 row_ror:4 row_mask:0xf bank_mask:0xf
  v_add_f32_dpp v112, v112, v112 row_ror:4 row_mask:0xf bank_mask:0xf
  v_add_f32_dpp v113, v113, v113 row_ror:4 row_mask:0xf bank_mask:0xf
  v_add_f32_dpp v114, v114, v114 row_ror:4 row_mask:0xf bank_mask:0xf
  v_add_f32_dpp v115, v115, v115 row_ror:4 row_mask:0xf bank_mask:0xf
  v_add_f32_dpp v116, v116, v116 row_ror:4 row_mask:0xf bank_mask:0xf
  v_add_f32_dpp v117, v117, v117 row_ror:4 row_mask:0xf bank_mask:0xf
  v_add_f32_dpp v118, v118, v118 row_ror:4 row_mask:0xf bank_mask:0xf
  v_add_f32_dpp v119, v119, v119 row_ror:4 row_mask:0xf bank_mask:0xf
  v_add_f32_dpp v120, v120, v120 row_ror:4 row_mask:0xf bank_mask:0xf
  v_add_f32_dpp v121, v121, v121 row_ror:4 row_mask:0xf bank_mask:0xf
  v_add_f32_dpp v122, v122, v122 row_ror:4 row_mask:0xf bank_mask:0xf
  v_add_f32_dpp v123, v123, v123 row_ror:4 row_mask:0xf bank_mask:0xf
  v_add_f32_dpp v124, v124, v124 row_ror:4 row_mask:0xf bank_mask:0xf
  v_add_f32_dpp v125, v125, v125 row_ror:4 row_mask:0xf bank_mask:0xf
  v_add_f32_dpp v126, v126, v126 row_ror:4 row_mask:0xf bank_mask:0xf
  v_add_f32_dpp v127, v127, v127 row_ror:4 row_mask:0xf bank_mask:0xf
  v_add_f32_dpp v128, v128, v128 row_ror:4 row_mask:0xf bank_mask:0xf
  v_add_f32_dpp v129, v129, v129 row_ror:4 row_mask:0xf bank_mask:0xf
  v_add_f32_dpp v130, v130, v130 row_ror:4 row_mask:0xf bank_mask:0xf
  v_add_f32_dpp v131, v131, v131 row_ror:4 row_mask:0xf bank_mask:0xf
  v_mov_b32 v82, v83
  v_mov_b32 v83, v84
  s_mov_b32 exec_lo, 0xf000f
  s_mov_b32 exec_hi, 0xf000f
  ds_write_b128 v134, v[100:103] offset:0
  ds_write_b128 v135, v[104:107] offset:0
  ds_write_b128 v136, v[108:111] offset:0
  ds_write_b128 v137, v[112:115] offset:0
  ds_write_b128 v134, v[116:119] offset:256
  ds_write_b128 v135, v[120:123] offset:256
  ds_write_b128 v136, v[124:127] offset:256
  ds_write_b128 v137, v[128:131] offset:256
  s_mov_b32 exec_lo, 0xf
  s_mov_b32 exec_hi, 0x0
  ds_write_b64 v138, v[82:83]
  s_mov_b64 exec, -1
  s_waitcnt lgkmcnt(0)
  s_barrier
  ds_read_b64 v[44:45], v140
  ds_read_b128 v[48:51], v139
  ds_read_b128 v[52:55], v139 offset:16
  s_waitcnt lgkmcnt(2)
  v_mov_b32 v46, v44
  s_nop 1
  v_max_f32_dpp v46, v46, v46 quad_perm:[1,0,3,2] row_mask:0xf bank_mask:0xf
  s_nop 1
  v_max_f32_dpp v46, v46, v46 quad_perm:[2,3,0,1] row_mask:0xf bank_mask:0xf
  s_nop 1
  v_max_f32_dpp v46, v46, v46 row_half_mirror row_mask:0xf bank_mask:0xf
  v_sub_f32 v44, v44, v46
  v_exp_f32 v44, v44
  s_waitcnt lgkmcnt(0)
  v_pk_mul_f32 v[48:49], v[48:49], v[44:45] op_sel_hi:[1,0]
  v_pk_mul_f32 v[50:51], v[50:51], v[44:45] op_sel_hi:[1,0]
  v_pk_mul_f32 v[52:53], v[52:53], v[44:45] op_sel_hi:[1,0]
  v_pk_mul_f32 v[54:55], v[54:55], v[44:45] op_sel_hi:[1,0]
  v_add_f32_dpp v48, v48, v48 row_half_mirror row_mask:0xf bank_mask:0x5
  v_add_f32_dpp v49, v49, v49 row_half_mirror row_mask:0xf bank_mask:0x5
  v_add_f32_dpp v50, v50, v50 row_half_mirror row_mask:0xf bank_mask:0x5
  v_add_f32_dpp v51, v51, v51 row_half_mirror row_mask:0xf bank_mask:0x5
  v_add_f32_dpp v48, v52, v52 row_half_mirror row_mask:0xf bank_mask:0xa
  v_add_f32_dpp v49, v53, v53 row_half_mirror row_mask:0xf bank_mask:0xa
  v_add_f32_dpp v50, v54, v54 row_half_mirror row_mask:0xf bank_mask:0xa
  v_add_f32_dpp v51, v55, v55 row_half_mirror row_mask:0xf bank_mask:0xa
  v_add_f32_dpp v48, v48, v48 quad_perm:[1,0,3,2] row_mask:0xf bank_mask:0xf
  v_add_f32_dpp v49, v49, v49 quad_perm:[1,0,3,2] row_mask:0xf bank_mask:0xf
  v_add_f32_dpp v50, v50, v50 quad_perm:[1,0,3,2] row_mask:0xf bank_mask:0xf
  v_add_f32_dpp v51, v51, v51 quad_perm:[1,0,3,2] row_mask:0xf bank_mask:0xf
  v_add_f32_dpp v48, v48, v48 quad_perm:[2,3,0,1] row_mask:0xf bank_mask:0xf
  v_add_f32_dpp v49, v49, v49 quad_perm:[2,3,0,1] row_mask:0xf bank_mask:0xf
  v_add_f32_dpp v50, v50, v50 quad_perm:[2,3,0,1] row_mask:0xf bank_mask:0xf
  v_add_f32_dpp v51, v51, v51 quad_perm:[2,3,0,1] row_mask:0xf bank_mask:0xf
  v_cvt_pk_bf16_f32 v48, v48, v49
  v_cvt_pk_bf16_f32 v49, v50, v51
  v_min_u32 v48, -2, v48
  v_min_u32 v49, -2, v49
  s_mov_b32 exec_lo, 0x11111111
  s_mov_b32 exec_hi, 0x11111111
  buffer_store_dwordx2 v[48:49], v141, s[12:15], 0 offen sc1
  s_mov_b64 exec, -1
  s_cmp_lt_u32 s81, 7
  s_cbranch_scc1 nopf_1417
  s_cmp_lt_u32 s81, 23
  s_cbranch_scc0 M_end
  s_and_b32 s88, s2, 7
  s_sub_u32 s86, s81, 7
  s_lshl_b32 s87, s86, 5
  s_lshl_b32 s98, s3, 2
  s_add_u32 s87, s87, s98
  v_bfe_u32 v3, v2, 3, 2
  v_add_u32 v3, s87, v3
  v_mul_u32_u24 v3, 3584, v3
  v_and_b32 v4, 7, v2
  v_min_u32 v4, 6, v4
  v_lshl_add_u32 v3, v4, 6, v3
  s_mul_i32 s87, s88, 448
  v_add_u32 v3, s87, v3
  s_mul_i32 s87, s88, 224
  s_mul_i32 s98, s86, 14
  s_add_u32 s87, s87, s98
  s_lshl_b32 s87, s87, 10
  s_mul_i32 s98, s3, 1792
  s_add_u32 s87, s87, s98
  v_min_u32 v4, 27, v2
  v_lshl_add_u32 v4, v4, 6, s87
  s_mov_b32 exec_hi, 0
  buffer_load_dword v6, v3, s[28:31], 0 offen
  buffer_load_dword v7, v3, s[32:35], 0 offen
  buffer_load_dword v9, v4, s[36:39], 0 offen
  s_mov_b64 exec, -1
  s_waitcnt vmcnt(0)
  s_branch M_end
nopf_1417:
  s_and_b32 s97, s2, 7
  s_mul_i32 s97, s97, 7
  s_add_u32 s97, s97, s81
  s_lshl_b32 s86, s3, 6
  v_and_b32 v8, 60, v2
  v_add_u32 v8, s86, v8
  v_mul_u32_u24 v8, 3584, v8
  v_and_b32 v3, 3, v2
  v_lshl_add_u32 v8, v3, 4, v8
  s_lshl_b32 s87, s97, 6
  v_add_u32 v8, s87, v8
  s_movk_i32 s98, 7168
  v_and_b32 v3, 7, v2
  v_lshrrev_b32 v4, 3, v2
  s_lshl_b32 s86, s97, 15
  s_lshl_b32 s87, s3, 7
  s_add_u32 s86, s86, s87
  v_lshlrev_b32 v9, 12, v4
  v_lshl_add_u32 v9, v3, 4, v9
  v_add_u32 v9, s86, v9
  s_barrier
  s_movk_i32 s98, 7168
  buffer_load_dwordx4 v[100:103], v8, s[28:31], 0 offen offset:0
  buffer_load_dwordx4 v[104:107], v8, s[28:31], 0 offen offset:3584
  buffer_load_dwordx4 v[108:111], v8, s[28:31], s98 offen offset:0
  buffer_load_dwordx4 v[112:115], v8, s[28:31], s98 offen offset:3584
  buffer_load_dwordx4 v[116:119], v8, s[32:35], 0 offen offset:0
  buffer_load_dwordx4 v[120:123], v8, s[32:35], 0 offen offset:3584
  buffer_load_dwordx4 v[124:127], v8, s[32:35], s98 offen offset:0
  buffer_load_dwordx4 v[128:131], v8, s[32:35], s98 offen offset:3584
  buffer_load_dwordx4 v[60:63], v9, s[36:39], 0 offen offset:0
  buffer_load_dwordx4 v[64:67], v9, s[36:39], 0 offen offset:1024
  buffer_load_dwordx4 v[68:71], v9, s[36:39], 0 offen offset:2048
  buffer_load_dwordx4 v[72:75], v9, s[36:39], 0 offen offset:3072
  v_and_b32 v3, 7, v2
  v_lshrrev_b32 v4, 3, v2
  v_and_b32 v6, 15, v2
  v_lshlrev_b32 v6, 2, v6
  v_bfe_u32 v7, v2, 5, 1
  v_lshl_add_u32 v6, v7, 1, v6
  v_bfe_u32 v7, v2, 4, 1
  v_add_u32 v6, v6, v7
  s_lshl_b32 s86, s3, 6
  v_add_u32 v6, s86, v6
  v_lshlrev_b32 v7, 1, v6
  v_add_u32 v7, 132096, v7
  ds_read_u16 v164, v7
  s_mov_b32 s82, 0x05040100
  s_mov_b32 s83, 0x07060302
  v_and_b32 v5, 15, v2
  v_lshrrev_b32 v7, 4, v2
  v_lshlrev_b32 v7, 12, v7
  v_lshl_add_u32 v7, v5, 4, v7
  s_lshl_b32 s87, s3, 8
  s_add_u32 s87, s87, 131072
  v_add_u32 v15, s87, v7
  v_lshlrev_b32 v17, 1, v6
  v_add_u32 v17, 8192, v17
  s_lshl_b32 s86, s3, 7
  s_add_u32 s86, s86, 8192
  v_lshrrev_b32 v7, 2, v2
  v_lshl_add_u32 v18, v7, 3, s86
  s_lshl_b32 s86, s3, 3
  s_add_u32 s86, s86, 9216
  v_mov_b32 v19, s86
  v_lshlrev_b32 v86, 3, v3
  v_add_u32 v86, 9216, v86
  v_and_b32 v5, 3, v2
  v_lshlrev_b32 v5, 3, v5
  v_bfe_u32 v7, v2, 5, 1
  v_lshl_add_u32 v5, v7, 5, v5
  v_bfe_u32 v7, v2, 4, 1
  v_lshl_add_u32 v5, v7, 2, v5
  v_bfe_u32 v7, v2, 3, 1
  v_lshl_add_u32 v5, v7, 1, v5
  v_bfe_u32 v7, v2, 2, 1
  v_add_u32 v5, v5, v7
  s_lshl_b32 s86, s3, 8
  s_add_u32 s86, s86, 10240
  v_lshl_add_u32 v87, v5, 2, s86
  v_lshlrev_b32 v88, 2, v2
  v_add_u32 v88, 10240, v88
  v_lshlrev_b32 v5, 3, v3
  v_bfe_u32 v7, v2, 5, 1
  v_lshl_add_u32 v5, v7, 2, v5
  v_bfe_u32 v7, v2, 4, 1
  v_lshl_add_u32 v5, v7, 1, v5
  v_bfe_u32 v7, v2, 3, 1
  v_add_u32 v5, v5, v7
  s_lshl_b32 s86, s97, 11
  s_lshl_b32 s87, s3, 8
  s_add_u32 s86, s86, s87
  s_add_u32 s86, s86, 262144
  v_lshl_add_u32 v89, v5, 2, s86
  v_lshlrev_b32 v90, 4, v4
  s_waitcnt vmcnt(0)
  s_mov_b32 s85, 0
  buffer_load_dwordx4 v[20:23], v15, s[12:15], 0 offen offset:0 sc1
  buffer_load_dwordx4 v[24:27], v15, s[12:15], 0 offen offset:2048 sc1
  s_waitcnt lgkmcnt(0)
  v_perm_b32 v98, v104, v100, s82
  v_perm_b32 v104, v104, v100, s83
  v_mov_b32 v100, v98
  v_perm_b32 v98, v105, v101, s82
  v_perm_b32 v105, v105, v101, s83
  v_mov_b32 v101, v98
  v_perm_b32 v98, v106, v102, s82
  v_perm_b32 v106, v106, v102, s83
  v_mov_b32 v102, v98
  v_perm_b32 v98, v107, v103, s82
  v_perm_b32 v107, v107, v103, s83
  v_mov_b32 v103, v98
  v_perm_b32 v98, v112, v108, s82
  v_perm_b32 v112, v112, v108, s83
  v_mov_b32 v108, v98
  v_perm_b32 v98, v113, v109, s82
  v_perm_b32 v113, v113, v109, s83
  v_mov_b32 v109, v98
  v_perm_b32 v98, v114, v110, s82
  v_perm_b32 v114, v114, v110, s83
  v_mov_b32 v110, v98
  v_perm_b32 v98, v115, v111, s82
  v_perm_b32 v115, v115, v111, s83
  v_mov_b32 v111, v98
  v_perm_b32 v98, v120, v116, s82
  v_perm_b32 v120, v120, v116, s83
  v_mov_b32 v116, v98
  v_perm_b32 v98, v121, v117, s82
  v_perm_b32 v121, v121, v117, s83
  v_mov_b32 v117, v98
  v_perm_b32 v98, v122, v118, s82
  v_perm_b32 v122, v122, v118, s83
  v_mov_b32 v118, v98
  v_perm_b32 v98, v123, v119, s82
  v_perm_b32 v123, v123, v119, s83
  v_mov_b32 v119, v98
  v_perm_b32 v98, v128, v124, s82
  v_perm_b32 v128, v128, v124, s83
  v_mov_b32 v124, v98
  v_perm_b32 v98, v129, v125, s82
  v_perm_b32 v129, v129, v125, s83
  v_mov_b32 v125, v98
  v_perm_b32 v98, v130, v126, s82
  v_perm_b32 v130, v130, v126, s83
  v_mov_b32 v126, v98
  v_perm_b32 v98, v131, v127, s82
  v_perm_b32 v131, v131, v127, s83
  v_mov_b32 v127, v98
  v_perm_b32 v98, v64, v60, s82
  v_perm_b32 v64, v64, v60, s83
  v_mov_b32 v60, v98
  v_perm_b32 v98, v65, v61, s82
  v_perm_b32 v65, v65, v61, s83
  v_mov_b32 v61, v98
  v_perm_b32 v98, v66, v62, s82
  v_perm_b32 v66, v66, v62, s83
  v_mov_b32 v62, v98
  v_perm_b32 v98, v67, v63, s82
  v_perm_b32 v67, v67, v63, s83
  v_mov_b32 v63, v98
  v_perm_b32 v98, v72, v68, s82
  v_perm_b32 v72, v72, v68, s83
  v_mov_b32 v68, v98
  v_perm_b32 v98, v73, v69, s82
  v_perm_b32 v73, v73, v69, s83
  v_mov_b32 v69, v98
  v_perm_b32 v98, v74, v70, s82
  v_perm_b32 v74, v74, v70, s83
  v_mov_b32 v70, v98
  v_perm_b32 v98, v75, v71, s82
  v_perm_b32 v75, v75, v71, s83
  v_mov_b32 v71, v98
  v_lshlrev_b32 v164, 16, v164
fg_w_1420:
  s_waitcnt vmcnt(0)
  v_max3_u32 v28, v20, v21, v22
  v_max_u32 v28, v28, v23
  v_cmp_eq_u32 vcc, -1, v28
  s_mov_b64 s[60:61], vcc
  v_max3_u32 v28, v24, v25, v26
  v_max_u32 v28, v28, v27
  v_cmp_eq_u32 vcc, -1, v28
  s_mov_b64 s[62:63], vcc
  s_or_b64 vcc, s[60:61], s[62:63]
  s_cbranch_vccz fg_d_1421
  s_add_u32 s85, s85, 1
  s_cmp_gt_u32 s85, 200000
  s_cbranch_scc1 M_end
  s_sleep 1
  s_mov_b64 exec, s[60:61]
  s_cbranch_execz fg_s_1422
  buffer_load_dwordx4 v[20:23], v15, s[12:15], 0 offen offset:0 sc1
fg_s_1422:
  s_mov_b64 exec, s[62:63]
  s_cbranch_execz fg_s_1423
  buffer_load_dwordx4 v[24:27], v15, s[12:15], 0 offen offset:2048 sc1
fg_s_1423:
  s_mov_b64 exec, -1
  s_branch fg_w_1420
fg_d_1421:
  v_pk_add_f32 v[20:21], v[20:21], v[24:25]
  v_pk_add_f32 v[22:23], v[22:23], v[26:27]
  s_nop 1
  v_permlane32_swap_b32 v20, v22
  v_permlane32_swap_b32 v21, v23
  v_pk_add_f32 v[20:21], v[20:21], v[22:23]
  s_nop 1
  v_permlane16_swap_b32 v20, v21
  v_add_f32 v20, v20, v21
  v_cvt_pk_bf16_f32 v20, v20, v20
  v_lshlrev_b32 v20, 16, v20
  v_add_f32 v20, v20, v164
  v_cvt_pk_bf16_f32 v20, v20, v20
  v_lshlrev_b32 v20, 16, v20
  v_mov_b32 v22, v20
  v_mul_f32 v23, v20, v20
  s_nop 0
  v_add_f32_dpp v22, v22, v22 quad_perm:[1,0,3,2] row_mask:0xf bank_mask:0xf
  v_add_f32_dpp v23, v23, v23 quad_perm:[1,0,3,2] row_mask:0xf bank_mask:0xf
  s_nop 0
  v_add_f32_dpp v22, v22, v22 quad_perm:[2,3,0,1] row_mask:0xf bank_mask:0xf
  v_add_f32_dpp v23, v23, v23 quad_perm:[2,3,0,1] row_mask:0xf bank_mask:0xf
  s_nop 0
  v_add_f32_dpp v22, v22, v22 row_ror:4 row_mask:0xf bank_mask:0xf
  v_add_f32_dpp v23, v23, v23 row_ror:4 row_mask:0xf bank_mask:0xf
  s_nop 0
  v_add_f32_dpp v22, v22, v22 row_ror:8 row_mask:0xf bank_mask:0xf
  v_add_f32_dpp v23, v23, v23 row_ror:8 row_mask:0xf bank_mask:0xf
  v_mov_b32 v24, v22
  v_mov_b32 v25, v23
  s_nop 0
  v_permlane16_swap_b32 v22, v24
  v_permlane16_swap_b32 v23, v25
  v_add_f32 v22, v22, v24
  v_add_f32 v23, v23, v25
  v_mov_b32 v24, v22
  v_mov_b32 v25, v23
  s_nop 0
  v_permlane32_swap_b32 v22, v24
  v_permlane32_swap_b32 v23, v25
  v_add_f32 v22, v22, v24
  v_add_f32 v23, v23, v25
  s_mov_b32 exec_lo, 0x1
  s_mov_b32 exec_hi, 0x0
  ds_write_b64 v19, v[22:23]
  s_mov_b64 exec, -1
  s_waitcnt lgkmcnt(0)
  s_barrier
  ds_read_b64 v[22:23], v86
  s_waitcnt lgkmcnt(0)
  v_add_f32_dpp v22, v22, v22 quad_perm:[1,0,3,2] row_mask:0xf bank_mask:0xf
  v_add_f32_dpp v23, v23, v23 quad_perm:[1,0,3,2] row_mask:0xf bank_mask:0xf
  s_nop 0
  v_add_f32_dpp v22, v22, v22 quad_perm:[2,3,0,1] row_mask:0xf bank_mask:0xf
  v_add_f32_dpp v23, v23, v23 quad_perm:[2,3,0,1] row_mask:0xf bank_mask:0xf
  s_nop 0
  v_add_f32_dpp v22, v22, v22 row_half_mirror row_mask:0xf bank_mask:0xf
  v_add_f32_dpp v23, v23, v23 row_half_mirror row_mask:0xf bank_mask:0xf
  v_mul_f32 v22, 0x3b000000, v22
  v_mul_f32 v23, 0x3b000000, v23
  v_fma_f32 v23, -v22, v22, v23
  v_cvt_pk_bf16_f32 v24, v22, v23
  v_lshlrev_b32 v22, 16, v24
  v_and_b32 v23, 0xffff0000, v24
  v_add_f32 v23, 0x3727c5ac, v23
  v_cvt_pk_bf16_f32 v23, v23, v23
  v_lshlrev_b32 v23, 16, v23
  v_sqrt_f32 v23, v23
  v_sub_f32 v20, v20, v22
  v_cvt_pk_bf16_f32 v23, v23, v23
  v_lshlrev_b32 v23, 16, v23
  v_cvt_pk_bf16_f32 v20, v20, v20
  v_lshlrev_b32 v20, 16, v20
  v_rcp_f32 v24, v23
  s_nop 0
  v_mul_f32 v25, v20, v24
  v_fma_f32 v20, -v25, v23, v20
  v_fma_f32 v20, v20, v24, v25
  v_cvt_pk_bf16_f32 v20, v20, v20
  ds_write_b16 v17, v20
  ds_read_b64 v[44:45], v18
  s_waitcnt lgkmcnt(0)
  v_dot2_f32_bf16 v24, v44, v100, 0
  v_dot2_f32_bf16 v25, v44, v104, 0
  v_dot2_f32_bf16 v26, v44, v101, 0
  v_dot2_f32_bf16 v27, v44, v105, 0
  v_dot2_f32_bf16 v28, v44, v102, 0
  v_dot2_f32_bf16 v29, v44, v106, 0
  v_dot2_f32_bf16 v30, v44, v103, 0
  v_dot2_f32_bf16 v31, v44, v107, 0
  v_dot2_f32_bf16 v24, v45, v108, v24
  v_dot2_f32_bf16 v25, v45, v112, v25
  v_dot2_f32_bf16 v26, v45, v109, v26
  v_dot2_f32_bf16 v27, v45, v113, v27
  v_dot2_f32_bf16 v28, v45, v110, v28
  v_dot2_f32_bf16 v29, v45, v114, v29
  v_dot2_f32_bf16 v30, v45, v111, v30
  v_dot2_f32_bf16 v31, v45, v115, v31
  v_dot2_f32_bf16 v32, v44, v116, 0
  v_dot2_f32_bf16 v33, v44, v120, 0
  v_dot2_f32_bf16 v34, v44, v117, 0
  v_dot2_f32_bf16 v35, v44, v121, 0
  v_dot2_f32_bf16 v36, v44, v118, 0
  v_dot2_f32_bf16 v37, v44, v122, 0
  v_dot2_f32_bf16 v38, v44, v119, 0
  v_dot2_f32_bf16 v39, v44, v123, 0
  v_dot2_f32_bf16 v32, v45, v124, v32
  v_dot2_f32_bf16 v33, v45, v128, v33
  v_dot2_f32_bf16 v34, v45, v125, v34
  v_dot2_f32_bf16 v35, v45, v129, v35
  v_dot2_f32_bf16 v36, v45, v126, v36
  v_dot2_f32_bf16 v37, v45, v130, v37
  v_dot2_f32_bf16 v38, v45, v127, v38
  v_dot2_f32_bf16 v39, v45, v131, v39
  v_permlane32_swap_b32 v24, v32
  v_permlane32_swap_b32 v25, v33
  v_permlane32_swap_b32 v26, v34
  v_permlane32_swap_b32 v27, v35
  v_permlane32_swap_b32 v28, v36
  v_permlane32_swap_b32 v29, v37
  v_permlane32_swap_b32 v30, v38
  v_permlane32_swap_b32 v31, v39
  v_pk_add_f32 v[24:25], v[24:25], v[32:33]
  v_pk_add_f32 v[26:27], v[26:27], v[34:35]
  v_pk_add_f32 v[28:29], v[28:29], v[36:37]
  v_pk_add_f32 v[30:31], v[30:31], v[38:39]
  s_nop 0
  v_permlane16_swap_b32 v24, v28
  v_permlane16_swap_b32 v25, v29
  v_permlane16_swap_b32 v26, v30
  v_permlane16_swap_b32 v27, v31
  v_pk_add_f32 v[24:25], v[24:25], v[28:29]
  v_pk_add_f32 v[26:27], v[26:27], v[30:31]
  s_nop 0
  v_add_f32_dpp v24, v24, v24 row_ror:8 row_mask:0xf bank_mask:0x3
  v_add_f32_dpp v25, v25, v25 row_ror:8 row_mask:0xf bank_mask:0x3
  s_nop 0
  v_add_f32_dpp v24, v26, v26 row_ror:8 row_mask:0xf bank_mask:0xc
  v_add_f32_dpp v25, v27, v27 row_ror:8 row_mask:0xf bank_mask:0xc
  s_nop 0
  v_add_f32_dpp v24, v24, v24 row_shl:4 row_mask:0xf bank_mask:0x5
  s_nop 1
  v_add_f32_dpp v24, v25, v25 row_shr:4 row_mask:0xf bank_mask:0xa
  ds_write_b32 v87, v24
  s_waitcnt lgkmcnt(0)
  s_barrier
  ds_read2st64_b32 v[44:45], v88 offset0:0 offset1:1
  ds_read2st64_b32 v[46:47], v88 offset0:2 offset1:3
  ds_read2st64_b32 v[48:49], v88 offset0:4 offset1:5
  ds_read2st64_b32 v[50:51], v88 offset0:6 offset1:7
  s_waitcnt lgkmcnt(0)
  v_pk_add_f32 v[44:45], v[44:45], v[46:47]
  v_pk_add_f32 v[48:49], v[48:49], v[50:51]
  v_pk_add_f32 v[44:45], v[44:45], v[48:49]
  v_add_f32 v44, v44, v45
  v_mov_b32 v45, v44
  s_nop 1
  v_permlane32_swap_b32 v44, v45
  v_cvt_pk_bf16_f32 v46, v44, v45
  v_lshlrev_b32 v44, 16, v46
  v_and_b32 v45, 0xffff0000, v46
  v_mul_f32 v46, v44, v44
  v_mov_b32 v47, 0x40135761
  v_fmac_f32 v47, 0x3dd2d3e8, v46
  v_mul_f32 v46, v44, v47
  v_exp_f32 v46, -v46
  s_nop 0
  v_add_f32 v46, 1.0, v46
  v_rcp_f32 v46, v46
  s_nop 0
  v_mul_f32 v44, v44, v46
  v_cvt_pk_bf16_f32 v44, v44, v44
  v_lshlrev_b32 v44, 16, v44
  v_mul_f32 v44, v44, v45
  v_cvt_pk_bf16_f32 v44, v44, v44
  s_nop 1
  v_mov_b32_dpp v45, v44 quad_perm:[1,0,3,2] row_mask:0xf bank_mask:0xf
  v_and_b32 v44, 0xffff, v44
  v_lshl_or_b32 v44, v45, 16, v44
  ds_bpermute_b32 v46, v90, v44
  ds_bpermute_b32 v47, v90, v44 offset:8
  s_waitcnt lgkmcnt(0)
  v_dot2_f32_bf16 v48, v46, v60, 0
  v_dot2_f32_bf16 v49, v46, v64, 0
  v_dot2_f32_bf16 v50, v46, v61, 0
  v_dot2_f32_bf16 v51, v46, v65, 0
  v_dot2_f32_bf16 v52, v46, v62, 0
  v_dot2_f32_bf16 v53, v46, v66, 0
  v_dot2_f32_bf16 v54, v46, v63, 0
  v_dot2_f32_bf16 v55, v46, v67, 0
  v_dot2_f32_bf16 v48, v47, v68, v48
  v_dot2_f32_bf16 v49, v47, v72, v49
  v_dot2_f32_bf16 v50, v47, v69, v50
  v_dot2_f32_bf16 v51, v47, v73, v51
  v_dot2_f32_bf16 v52, v47, v70, v52
  v_dot2_f32_bf16 v53, v47, v74, v53
  v_dot2_f32_bf16 v54, v47, v71, v54
  v_dot2_f32_bf16 v55, v47, v75, v55
  v_permlane32_swap_b32 v48, v52
  v_permlane32_swap_b32 v49, v53
  v_permlane32_swap_b32 v50, v54
  v_permlane32_swap_b32 v51, v55
  v_pk_add_f32 v[48:49], v[48:49], v[52:53]
  v_pk_add_f32 v[50:51], v[50:51], v[54:55]
  s_nop 1
  v_permlane16_swap_b32 v48, v50
  v_permlane16_swap_b32 v49, v51
  v_pk_add_f32 v[48:49], v[48:49], v[50:51]
  s_nop 1
  v_add_f32_dpp v48, v48, v48 row_ror:8 row_mask:0xf bank_mask:0x3
  s_nop 1
  v_add_f32_dpp v48, v49, v49 row_ror:8 row_mask:0xf bank_mask:0xc
  v_min_u32 v48, -2, v48
  buffer_store_dword v48, v89, s[12:15], 0 offen sc1
  s_branch M_end
L_svc:
  s_sub_u32 s96, s81, 24
  s_and_b32 s97, s2, 7
  s_mul_i32 s97, s97, 7
  s_add_u32 s97, s97, s96
  s_mov_b32 s82, 0x05040100
  s_mov_b32 s83, 0x07060302
  s_waitcnt lgkmcnt(0)
  s_mov_b32 s12, s78
  s_and_b32 s13, s79, 0xffff
  s_mov_b32 s14, 0x400000
  s_mov_b32 s15, 0x20000
  s_mov_b32 s24, s64
  s_and_b32 s25, s65, 0xffff
  s_mov_b32 s26, 0x400000
  s_mov_b32 s27, 0x20000
  s_mov_b32 s28, s68
  s_and_b32 s29, s69, 0xffff
  s_mov_b32 s30, 0x1c0000
  s_mov_b32 s31, 0x20000
  s_mov_b32 s32, s70
  s_and_b32 s33, s71, 0xffff
  s_mov_b32 s34, 0x1c0000
  s_mov_b32 s35, 0x20000
  s_mov_b32 s36, s72
  s_and_b32 s37, s73, 0xffff
  s_mov_b32 s38, 0x1c0000
  s_mov_b32 s39, 0x20000
  s_mov_b32 s48, s74
  s_and_b32 s49, s75, 0xffff
  s_mov_b32 s50, 0x400
  s_mov_b32 s51, 0x20000
  s_mov_b32 s16, s56
  s_and_b32 s17, s57, 0xffff
  s_mov_b32 s18, 0x400
  s_mov_b32 s19, 0x20000
  s_mov_b32 s87, 4096
  s_mov_b32 s88, 8192
  s_mov_b32 s89, 12288
  s_mov_b32 s90, 16384
  s_mov_b32 s91, 20480
  s_mov_b32 s92, 24576
  s_mov_b32 s93, 28672
  v_and_b32 v3, 7, v2
  v_lshrrev_b32 v4, 3, v2
  s_lshl_b32 s98, s80, 19
  s_lshl_b32 s99, s3, 16
  s_add_u32 s98, s98, s99
  s_lshl_b32 s99, s96, 7
  s_add_u32 s98, s98, s99
  v_lshlrev_b32 v5, 13, v3
  v_lshl_add_u32 v5, v4, 4, v5
  v_add_u32 v5, s98, v5
  buffer_load_dwordx4 v[100:103], v5, s[24:27], 0 offen offset:0 nt
  buffer_load_dwordx4 v[104:107], v5, s[24:27], 0 offen offset:1024 nt
  buffer_load_dwordx4 v[108:111], v5, s[24:27], 0 offen offset:2048 nt
  buffer_load_dwordx4 v[112:115], v5, s[24:27], 0 offen offset:3072 nt
  buffer_load_dwordx4 v[116:119], v5, s[24:27], s87 offen offset:0 nt
  buffer_load_dwordx4 v[120:123], v5, s[24:27], s87 offen offset:1024 nt
  buffer_load_dwordx4 v[124:127], v5, s[24:27], s87 offen offset:2048 nt
  buffer_load_dwordx4 v[128:131], v5, s[24:27], s87 offen offset:3072 nt
  v_and_b32 v6, 15, v2
  v_lshlrev_b32 v6, 2, v6
  v_bfe_u32 v7, v2, 5, 1
  v_lshl_add_u32 v6, v7, 1, v6
  v_bfe_u32 v7, v2, 4, 1
  v_add_u32 v6, v6, v7
  s_lshl_b32 s98, s3, 6
  v_add_u32 v6, s98, v6
  v_lshlrev_b32 v7, 1, v6
  buffer_load_ushort v164, v7, s[16:19], 0 offen
  s_branch nof_1424
  s_lshl_b32 s98, s3, 6
  v_lshlrev_b32 v8, 3, v3
  v_add_u32 v8, s98, v8
  v_mul_u32_u24 v8, 3584, v8
  v_and_b32 v9, 3, v4
  v_lshl_add_u32 v8, v9, 4, v8
  s_lshl_b32 s98, s97, 6
  v_add_u32 v8, s98, v8
  s_mov_b32 exec_lo, 0xffffffff
  s_mov_b32 exec_hi, 0x0
  buffer_load_dwordx4 v[132:135], v8, s[28:31], 0 offen nt
  s_mov_b32 s99, 3584
  buffer_load_dwordx4 v[136:139], v8, s[28:31], s99 offen nt
  s_mov_b32 s99, 7168
  buffer_load_dwordx4 v[140:143], v8, s[28:31], s99 offen nt
  s_mov_b32 s99, 10752
  buffer_load_dwordx4 v[144:147], v8, s[28:31], s99 offen nt
  s_mov_b32 s99, 14336
  buffer_load_dwordx4 v[148:151], v8, s[28:31], s99 offen nt
  s_mov_b32 s99, 17920
  buffer_load_dwordx4 v[152:155], v8, s[28:31], s99 offen nt
  s_mov_b32 s99, 21504
  buffer_load_dwordx4 v[156:159], v8, s[28:31], s99 offen nt
  s_mov_b32 s99, 25088
  buffer_load_dwordx4 v[160:163], v8, s[28:31], s99 offen nt
  s_mov_b32 exec_lo, 0x0
  s_mov_b32 exec_hi, 0xffffffff
  buffer_load_dwordx4 v[132:135], v8, s[32:35], 0 offen nt
  s_mov_b32 s99, 3584
  buffer_load_dwordx4 v[136:139], v8, s[32:35], s99 offen nt
  s_mov_b32 s99, 7168
  buffer_load_dwordx4 v[140:143], v8, s[32:35], s99 offen nt
  s_mov_b32 s99, 10752
  buffer_load_dwordx4 v[144:147], v8, s[32:35], s99 offen nt
  s_mov_b32 s99, 14336
  buffer_load_dwordx4 v[148:151], v8, s[32:35], s99 offen nt
  s_mov_b32 s99, 17920
  buffer_load_dwordx4 v[152:155], v8, s[32:35], s99 offen nt
  s_mov_b32 s99, 21504
  buffer_load_dwordx4 v[156:159], v8, s[32:35], s99 offen nt
  s_mov_b32 s99, 25088
  buffer_load_dwordx4 v[160:163], v8, s[32:35], s99 offen nt
  s_mov_b64 exec, -1
  s_lshl_b32 s98, s97, 15
  s_lshl_b32 s99, s3, 7
  s_add_u32 s98, s98, s99
  v_lshlrev_b32 v9, 1, v2
  v_add_u32 v9, s98, v9
  buffer_load_ushort v20, v9, s[36:39], 0 offen offset:0 nt
  buffer_load_ushort v21, v9, s[36:39], 0 offen offset:1024 nt
  buffer_load_ushort v22, v9, s[36:39], 0 offen offset:2048 nt
  buffer_load_ushort v23, v9, s[36:39], 0 offen offset:3072 nt
  buffer_load_ushort v24, v9, s[36:39], s87 offen offset:0 nt
  buffer_load_ushort v25, v9, s[36:39], s87 offen offset:1024 nt
  buffer_load_ushort v26, v9, s[36:39], s87 offen offset:2048 nt
  buffer_load_ushort v27, v9, s[36:39], s87 offen offset:3072 nt
  buffer_load_ushort v28, v9, s[36:39], s88 offen offset:0 nt
  buffer_load_ushort v29, v9, s[36:39], s88 offen offset:1024 nt
  buffer_load_ushort v30, v9, s[36:39], s88 offen offset:2048 nt
  buffer_load_ushort v31, v9, s[36:39], s88 offen offset:3072 nt
  buffer_load_ushort v32, v9, s[36:39], s89 offen offset:0 nt
  buffer_load_ushort v33, v9, s[36:39], s89 offen offset:1024 nt
  buffer_load_ushort v34, v9, s[36:39], s89 offen offset:2048 nt
  buffer_load_ushort v35, v9, s[36:39], s89 offen offset:3072 nt
  buffer_load_ushort v36, v9, s[36:39], s90 offen offset:0 nt
  buffer_load_ushort v37, v9, s[36:39], s90 offen offset:1024 nt
  buffer_load_ushort v38, v9, s[36:39], s90 offen offset:2048 nt
  buffer_load_ushort v39, v9, s[36:39], s90 offen offset:3072 nt
  buffer_load_ushort v40, v9, s[36:39], s91 offen offset:0 nt
  buffer_load_ushort v41, v9, s[36:39], s91 offen offset:1024 nt
  buffer_load_ushort v42, v9, s[36:39], s91 offen offset:2048 nt
  buffer_load_ushort v43, v9, s[36:39], s91 offen offset:3072 nt
  buffer_load_ushort v44, v9, s[36:39], s92 offen offset:0 nt
  buffer_load_ushort v45, v9, s[36:39], s92 offen offset:1024 nt
  buffer_load_ushort v46, v9, s[36:39], s92 offen offset:2048 nt
  buffer_load_ushort v47, v9, s[36:39], s92 offen offset:3072 nt
  buffer_load_ushort v48, v9, s[36:39], s93 offen offset:0 nt
  buffer_load_ushort v49, v9, s[36:39], s93 offen offset:1024 nt
  buffer_load_ushort v50, v9, s[36:39], s93 offen offset:2048 nt
  buffer_load_ushort v51, v9, s[36:39], s93 offen offset:3072 nt
  s_waitcnt vmcnt(0)
  v_lshl_or_b32 v60, v21, 16, v20
  v_lshl_or_b32 v61, v23, 16, v22
  v_lshl_or_b32 v62, v25, 16, v24
  v_lshl_or_b32 v63, v27, 16, v26
  v_lshl_or_b32 v64, v29, 16, v28
  v_lshl_or_b32 v65, v31, 16, v30
  v_lshl_or_b32 v66, v33, 16, v32
  v_lshl_or_b32 v67, v35, 16, v34
  v_lshl_or_b32 v68, v37, 16, v36
  v_lshl_or_b32 v69, v39, 16, v38
  v_lshl_or_b32 v70, v41, 16, v40
  v_lshl_or_b32 v71, v43, 16, v42
  v_lshl_or_b32 v72, v45, 16, v44
  v_lshl_or_b32 v73, v47, 16, v46
  v_lshl_or_b32 v74, v49, 16, v48
  v_lshl_or_b32 v75, v51, 16, v50
  v_perm_b32 v98, v136, v132, s82
  v_perm_b32 v136, v136, v132, s83
  v_mov_b32 v132, v98
  v_perm_b32 v98, v137, v133, s82
  v_perm_b32 v137, v137, v133, s83
  v_mov_b32 v133, v98
  v_perm_b32 v98, v138, v134, s82
  v_perm_b32 v138, v138, v134, s83
  v_mov_b32 v134, v98
  v_perm_b32 v98, v139, v135, s82
  v_perm_b32 v139, v139, v135, s83
  v_mov_b32 v135, v98
  v_perm_b32 v98, v144, v140, s82
  v_perm_b32 v144, v144, v140, s83
  v_mov_b32 v140, v98
  v_perm_b32 v98, v145, v141, s82
  v_perm_b32 v145, v145, v141, s83
  v_mov_b32 v141, v98
  v_perm_b32 v98, v146, v142, s82
  v_perm_b32 v146, v146, v142, s83
  v_mov_b32 v142, v98
  v_perm_b32 v98, v147, v143, s82
  v_perm_b32 v147, v147, v143, s83
  v_mov_b32 v143, v98
  v_perm_b32 v98, v152, v148, s82
  v_perm_b32 v152, v152, v148, s83
  v_mov_b32 v148, v98
  v_perm_b32 v98, v153, v149, s82
  v_perm_b32 v153, v153, v149, s83
  v_mov_b32 v149, v98
  v_perm_b32 v98, v154, v150, s82
  v_perm_b32 v154, v154, v150, s83
  v_mov_b32 v150, v98
  v_perm_b32 v98, v155, v151, s82
  v_perm_b32 v155, v155, v151, s83
  v_mov_b32 v151, v98
  v_perm_b32 v98, v160, v156, s82
  v_perm_b32 v160, v160, v156, s83
  v_mov_b32 v156, v98
  v_perm_b32 v98, v161, v157, s82
  v_perm_b32 v161, v161, v157, s83
  v_mov_b32 v157, v98
  v_perm_b32 v98, v162, v158, s82
  v_perm_b32 v162, v162, v158, s83
  v_mov_b32 v158, v98
  v_perm_b32 v98, v163, v159, s82
  v_perm_b32 v163, v163, v159, s83
  v_mov_b32 v159, v98
nof_1424:
  s_waitcnt vmcnt(0)
  v_perm_b32 v98, v104, v100, s82
  v_perm_b32 v104, v104, v100, s83
  v_mov_b32 v100, v98
  v_perm_b32 v98, v105, v101, s82
  v_perm_b32 v105, v105, v101, s83
  v_mov_b32 v101, v98
  v_perm_b32 v98, v106, v102, s82
  v_perm_b32 v106, v106, v102, s83
  v_mov_b32 v102, v98
  v_perm_b32 v98, v107, v103, s82
  v_perm_b32 v107, v107, v103, s83
  v_mov_b32 v103, v98
  v_perm_b32 v98, v112, v108, s82
  v_perm_b32 v112, v112, v108, s83
  v_mov_b32 v108, v98
  v_perm_b32 v98, v113, v109, s82
  v_perm_b32 v113, v113, v109, s83
  v_mov_b32 v109, v98
  v_perm_b32 v98, v114, v110, s82
  v_perm_b32 v114, v114, v110, s83
  v_mov_b32 v110, v98
  v_perm_b32 v98, v115, v111, s82
  v_perm_b32 v115, v115, v111, s83
  v_mov_b32 v111, v98
  v_perm_b32 v98, v120, v116, s82
  v_perm_b32 v120, v120, v116, s83
  v_mov_b32 v116, v98
  v_perm_b32 v98, v121, v117, s82
  v_perm_b32 v121, v121, v117, s83
  v_mov_b32 v117, v98
  v_perm_b32 v98, v122, v118, s82
  v_perm_b32 v122, v122, v118, s83
  v_mov_b32 v118, v98
  v_perm_b32 v98, v123, v119, s82
  v_perm_b32 v123, v123, v119, s83
  v_mov_b32 v119, v98
  v_perm_b32 v98, v128, v124, s82
  v_perm_b32 v128, v128, v124, s83
  v_mov_b32 v124, v98
  v_perm_b32 v98, v129, v125, s82
  v_perm_b32 v129, v129, v125, s83
  v_mov_b32 v125, v98
  v_perm_b32 v98, v130, v126, s82
  v_perm_b32 v130, v130, v126, s83
  v_mov_b32 v126, v98
  v_perm_b32 v98, v131, v127, s82
  v_perm_b32 v131, v131, v127, s83
  v_mov_b32 v127, v98
  v_lshlrev_b32 v164, 16, v164
  s_mul_i32 s86, s80, 24576
  s_lshl_b32 s87, s3, 7
  s_add_u32 s86, s86, s87
  s_add_u32 s86, s86, 1048576
  v_lshlrev_b32 v10, 10, v4
  v_lshl_add_u32 v10, v3, 4, v10
  v_add_u32 v10, s86, v10
  s_mul_i32 s86, s80, 768
  s_lshr_b32 s87, s3, 1
  s_lshl_b32 s87, s87, 3
  s_add_u32 s86, s86, s87
  s_add_u32 s86, s86, 65536
  s_lshr_b32 s87, s3, 1
  s_lshl_b32 s87, s87, 7
  s_add_u32 s87, s87, 8192
  v_lshl_add_u32 v11, v4, 4, s87
  s_lshl_b32 s86, s3, 8
  v_lshrrev_b32 v5, 2, v2
  v_lshlrev_b32 v5, 4, v5
  v_add_u32 v5, s86, v5
  v_add_u32 v12, 0, v5
  v_add_u32 v87, 6144, v5
  v_lshlrev_b32 v5, 2, v2
  v_add_u32 v13, 0, v5
  v_add_u32 v88, 6144, v5
  s_lshl_b32 s86, s80, 11
  s_lshl_b32 s87, s96, 8
  s_add_u32 s86, s86, s87
  s_add_u32 s86, s86, 131072
  v_add_u32 v14, s86, v5
  s_lshl_b32 s86, s97, 11
  s_lshl_b32 s87, s3, 8
  s_add_u32 s86, s86, s87
  s_add_u32 s86, s86, 262144
  v_add_u32 v89, s86, v5
  s_lshl_b32 s87, s3, 8
  v_and_b32 v5, 15, v2
  v_lshrrev_b32 v7, 4, v2
  v_lshlrev_b32 v7, 12, v7
  v_lshl_add_u32 v7, v5, 4, v7
  s_add_u32 s87, s87, 131072
  v_add_u32 v15, s87, v7
  v_lshlrev_b32 v16, 2, v6
  v_add_u32 v16, 2048, v16
  v_lshlrev_b32 v17, 1, v6
  v_add_u32 v17, 4096, v17
  s_lshl_b32 s86, s3, 7
  s_add_u32 s86, s86, 4096
  v_lshl_add_u32 v18, v3, 4, s86
  s_lshl_b32 s86, s3, 3
  s_add_u32 s86, s86, 5120
  v_mov_b32 v19, s86
  v_lshlrev_b32 v86, 3, v3
  v_add_u32 v86, 5120, v86
  s_lshl_b32 s86, s80, 1
  s_add_u32 s86, s86, s3
  s_lshl_b32 s87, s86, 7
  s_add_u32 s87, s87, 262144
  v_lshlrev_b32 v5, 11, v4
  v_lshl_add_u32 v5, v3, 4, v5
  v_add_u32 v90, s87, v5
  v_lshlrev_b32 v5, 2, v3
  v_bfe_u32 v7, v2, 5, 1
  v_lshl_add_u32 v5, v7, 1, v5
  v_bfe_u32 v7, v2, 4, 1
  v_add_u32 v5, v5, v7
  s_lshl_b32 s86, s86, 5
  v_add_u32 v5, s86, v5
  v_lshlrev_b32 v92, 1, v5
  v_lshlrev_b32 v91, 2, v5
  v_add_u32 v91, 2048, v91
  s_mov_b32 s98, 8192
  s_mov_b32 s99, 16384
  s_barrier
  s_mov_b32 s85, 0
  buffer_load_dwordx4 v[20:23], v10, s[12:15], 0 offen sc1
  buffer_load_dwordx4 v[24:27], v10, s[12:15], s98 offen sc1
  buffer_load_dwordx4 v[28:31], v10, s[12:15], s99 offen sc1
wg_w_1425:
  s_waitcnt vmcnt(0)
  v_max3_u32 v39, v20, v21, v22
  v_max_u32 v39, v39, v23
  v_cmp_eq_u32 vcc, -1, v39
  s_mov_b64 s[60:61], vcc
  v_max3_u32 v39, v24, v25, v26
  v_max_u32 v39, v39, v27
  v_cmp_eq_u32 vcc, -1, v39
  s_mov_b64 s[62:63], vcc
  v_max3_u32 v39, v28, v29, v30
  v_max_u32 v39, v39, v31
  v_cmp_eq_u32 vcc, -1, v39
  s_mov_b64 s[64:65], vcc
  s_or_b64 vcc, s[60:61], s[62:63]
  s_or_b64 vcc, vcc, s[64:65]
  s_cbranch_vccz wg_d_1426
  s_add_u32 s85, s85, 1
  s_cmp_gt_u32 s85, 200000
  s_cbranch_scc1 M_end
  s_sleep 1
  s_mov_b64 exec, s[60:61]
  s_cbranch_execz wg_s_1427
  buffer_load_dwordx4 v[20:23], v10, s[12:15], 0 offen sc1
wg_s_1427:
  s_mov_b64 exec, s[62:63]
  s_cbranch_execz wg_s_1428
  buffer_load_dwordx4 v[24:27], v10, s[12:15], s98 offen sc1
wg_s_1428:
  s_mov_b64 exec, s[64:65]
  s_cbranch_execz wg_s_1429
  buffer_load_dwordx4 v[28:31], v10, s[12:15], s99 offen sc1
wg_s_1429:
  s_mov_b64 exec, -1
  s_branch wg_w_1425
wg_d_1426:
  s_barrier
  ds_read_b128 v[40:43], v11
  s_waitcnt lgkmcnt(0)
  v_lshrrev_b32 v36, 16, v40
  v_lshrrev_b32 v37, 16, v41
  v_lshrrev_b32 v38, 16, v42
  v_dot2_f32_bf16 v76, v20, v36, 0
  v_dot2_f32_bf16 v77, v20, v40, 0
  v_dot2_f32_bf16 v78, v21, v36, 0
  v_dot2_f32_bf16 v79, v21, v40, 0
  v_dot2_f32_bf16 v80, v22, v36, 0
  v_dot2_f32_bf16 v81, v22, v40, 0
  v_dot2_f32_bf16 v82, v23, v36, 0
  v_dot2_f32_bf16 v83, v23, v40, 0
  v_dot2_f32_bf16 v76, v24, v37, v76
  v_dot2_f32_bf16 v77, v24, v41, v77
  v_dot2_f32_bf16 v78, v25, v37, v78
  v_dot2_f32_bf16 v79, v25, v41, v79
  v_dot2_f32_bf16 v80, v26, v37, v80
  v_dot2_f32_bf16 v81, v26, v41, v81
  v_dot2_f32_bf16 v82, v27, v37, v82
  v_dot2_f32_bf16 v83, v27, v41, v83
  v_dot2_f32_bf16 v76, v28, v38, v76
  v_dot2_f32_bf16 v77, v28, v42, v77
  v_dot2_f32_bf16 v78, v29, v38, v78
  v_dot2_f32_bf16 v79, v29, v42, v79
  v_dot2_f32_bf16 v80, v30, v38, v80
  v_dot2_f32_bf16 v81, v30, v42, v81
  v_dot2_f32_bf16 v82, v31, v38, v82
  v_dot2_f32_bf16 v83, v31, v42, v83
  v_permlane32_swap_b32 v76, v80
  v_permlane32_swap_b32 v77, v81
  v_permlane32_swap_b32 v78, v82
  v_permlane32_swap_b32 v79, v83
  v_pk_add_f32 v[76:77], v[76:77], v[80:81]
  v_pk_add_f32 v[78:79], v[78:79], v[82:83]
  s_nop 1
  v_permlane16_swap_b32 v76, v78
  v_permlane16_swap_b32 v77, v79
  v_pk_add_f32 v[76:77], v[76:77], v[78:79]
  s_nop 1
  v_add_f32_dpp v76, v76, v76 row_ror:8 row_mask:0xf bank_mask:0xf
  v_add_f32_dpp v77, v77, v77 row_ror:8 row_mask:0xf bank_mask:0xf
  v_pk_mul_f32 v[76:77], v[76:77], v[42:43] op_sel:[0,1] op_sel_hi:[1,1]
  s_nop 0
  v_cvt_pk_bf16_f32 v44, v76, v77
  v_mov_b32 v45, v44
  s_nop 1
  v_permlane16_swap_b32 v44, v45
  v_mov_b32 v46, v44
  v_mov_b32 v47, v45
  s_nop 0
  v_permlane32_swap_b32 v44, v46
  v_permlane32_swap_b32 v45, v47
  v_dot2_f32_bf16 v76, v44, v100, 0
  v_dot2_f32_bf16 v77, v44, v104, 0
  v_dot2_f32_bf16 v78, v44, v101, 0
  v_dot2_f32_bf16 v79, v44, v105, 0
  v_dot2_f32_bf16 v80, v44, v102, 0
  v_dot2_f32_bf16 v81, v44, v106, 0
  v_dot2_f32_bf16 v82, v44, v103, 0
  v_dot2_f32_bf16 v83, v44, v107, 0
  v_dot2_f32_bf16 v76, v45, v108, v76
  v_dot2_f32_bf16 v77, v45, v112, v77
  v_dot2_f32_bf16 v78, v45, v109, v78
  v_dot2_f32_bf16 v79, v45, v113, v79
  v_dot2_f32_bf16 v80, v45, v110, v80
  v_dot2_f32_bf16 v81, v45, v114, v81
  v_dot2_f32_bf16 v82, v45, v111, v82
  v_dot2_f32_bf16 v83, v45, v115, v83
  v_dot2_f32_bf16 v76, v46, v116, v76
  v_dot2_f32_bf16 v77, v46, v120, v77
  v_dot2_f32_bf16 v78, v46, v117, v78
  v_dot2_f32_bf16 v79, v46, v121, v79
  v_dot2_f32_bf16 v80, v46, v118, v80
  v_dot2_f32_bf16 v81, v46, v122, v81
  v_dot2_f32_bf16 v82, v46, v119, v82
  v_dot2_f32_bf16 v83, v46, v123, v83
  v_dot2_f32_bf16 v76, v47, v124, v76
  v_dot2_f32_bf16 v77, v47, v128, v77
  v_dot2_f32_bf16 v78, v47, v125, v78
  v_dot2_f32_bf16 v79, v47, v129, v79
  v_dot2_f32_bf16 v80, v47, v126, v80
  v_dot2_f32_bf16 v81, v47, v130, v81
  v_dot2_f32_bf16 v82, v47, v127, v82
  v_dot2_f32_bf16 v83, v47, v131, v83
  v_add_f32_dpp v76, v76, v76 row_half_mirror row_mask:0xf bank_mask:0x5
  v_add_f32_dpp v77, v77, v77 row_half_mirror row_mask:0xf bank_mask:0x5
  v_add_f32_dpp v78, v78, v78 row_half_mirror row_mask:0xf bank_mask:0x5
  v_add_f32_dpp v79, v79, v79 row_half_mirror row_mask:0xf bank_mask:0x5
  v_add_f32_dpp v76, v80, v80 row_half_mirror row_mask:0xf bank_mask:0xa
  v_add_f32_dpp v77, v81, v81 row_half_mirror row_mask:0xf bank_mask:0xa
  v_add_f32_dpp v78, v82, v82 row_half_mirror row_mask:0xf bank_mask:0xa
  v_add_f32_dpp v79, v83, v83 row_half_mirror row_mask:0xf bank_mask:0xa
  v_add_f32_dpp v76, v76, v76 quad_perm:[1,0,3,2] row_mask:0xf bank_mask:0xf
  v_add_f32_dpp v77, v77, v77 quad_perm:[1,0,3,2] row_mask:0xf bank_mask:0xf
  v_add_f32_dpp v78, v78, v78 quad_perm:[1,0,3,2] row_mask:0xf bank_mask:0xf
  v_add_f32_dpp v79, v79, v79 quad_perm:[1,0,3,2] row_mask:0xf bank_mask:0xf
  v_add_f32_dpp v76, v76, v76 quad_perm:[2,3,0,1] row_mask:0xf bank_mask:0xf
  v_add_f32_dpp v77, v77, v77 quad_perm:[2,3,0,1] row_mask:0xf bank_mask:0xf
  v_add_f32_dpp v78, v78, v78 quad_perm:[2,3,0,1] row_mask:0xf bank_mask:0xf
  v_add_f32_dpp v79, v79, v79 quad_perm:[2,3,0,1] row_mask:0xf bank_mask:0xf
  s_mov_b32 exec_lo, 0x11111111
  s_mov_b32 exec_hi, 0x11111111
  ds_write_b128 v12, v[76:79]
  s_mov_b64 exec, -1
  s_waitcnt lgkmcnt(0)
  s_barrier
  s_cmp_lg_u32 s3, 0
  s_cbranch_scc1 wskip_1430
  ds_read2st64_b32 v[76:77], v13 offset0:0 offset1:1
  ds_read2st64_b32 v[78:79], v13 offset0:2 offset1:3
  ds_read2st64_b32 v[80:81], v13 offset0:4 offset1:5
  ds_read2st64_b32 v[82:83], v13 offset0:6 offset1:7
  s_waitcnt lgkmcnt(0)
  v_pk_add_f32 v[76:77], v[76:77], v[78:79]
  v_pk_add_f32 v[80:81], v[80:81], v[82:83]
  v_pk_add_f32 v[76:77], v[76:77], v[80:81]
  v_add_f32 v76, v76, v77
  v_min_u32 v76, -2, v76
  buffer_store_dword v76, v14, s[12:15], 0 offen sc1
wskip_1430:
  s_cmp_lt_u32 s96, 7
  s_cbranch_scc1 M_end
  s_mov_b32 s85, 0
  buffer_load_dwordx4 v[20:23], v15, s[12:15], 0 offen offset:0 sc1
  buffer_load_dwordx4 v[24:27], v15, s[12:15], 0 offen offset:2048 sc1
fg_w_1431:
  s_waitcnt vmcnt(0)
  v_max3_u32 v28, v20, v21, v22
  v_max_u32 v28, v28, v23
  v_cmp_eq_u32 vcc, -1, v28
  s_mov_b64 s[60:61], vcc
  v_max3_u32 v28, v24, v25, v26
  v_max_u32 v28, v28, v27
  v_cmp_eq_u32 vcc, -1, v28
  s_mov_b64 s[62:63], vcc
  s_or_b64 vcc, s[60:61], s[62:63]
  s_cbranch_vccz fg_d_1432
  s_add_u32 s85, s85, 1
  s_cmp_gt_u32 s85, 200000
  s_cbranch_scc1 M_end
  s_sleep 1
  s_mov_b64 exec, s[60:61]
  s_cbranch_execz fg_s_1433
  buffer_load_dwordx4 v[20:23], v15, s[12:15], 0 offen offset:0 sc1
fg_s_1433:
  s_mov_b64 exec, s[62:63]
  s_cbranch_execz fg_s_1434
  buffer_load_dwordx4 v[24:27], v15, s[12:15], 0 offen offset:2048 sc1
fg_s_1434:
  s_mov_b64 exec, -1
  s_branch fg_w_1431
fg_d_1432:
  v_add_f32 v20, v20, v24
  v_add_f32 v21, v21, v25
  v_add_f32 v22, v22, v26
  v_add_f32 v23, v23, v27
  s_nop 0
  v_permlane32_swap_b32 v20, v22
  v_permlane32_swap_b32 v21, v23
  v_add_f32 v20, v20, v22
  v_add_f32 v21, v21, v23
  s_nop 1
  v_permlane16_swap_b32 v20, v21
  v_add_f32 v20, v20, v21
  v_cvt_pk_bf16_f32 v20, v20, v20
  v_lshlrev_b32 v20, 16, v20
  v_add_f32 v20, v20, v164
  v_cvt_pk_bf16_f32 v20, v20, v20
  v_lshlrev_b32 v20, 16, v20
  ds_write_b32 v16, v20
  v_mov_b32 v22, v20
  v_mul_f32 v23, v20, v20
  s_nop 0
  v_add_f32_dpp v22, v22, v22 quad_perm:[1,0,3,2] row_mask:0xf bank_mask:0xf
  v_add_f32_dpp v23, v23, v23 quad_perm:[1,0,3,2] row_mask:0xf bank_mask:0xf
  s_nop 0
  v_add_f32_dpp v22, v22, v22 quad_perm:[2,3,0,1] row_mask:0xf bank_mask:0xf
  v_add_f32_dpp v23, v23, v23 quad_perm:[2,3,0,1] row_mask:0xf bank_mask:0xf
  s_nop 0
  v_add_f32_dpp v22, v22, v22 row_ror:4 row_mask:0xf bank_mask:0xf
  v_add_f32_dpp v23, v23, v23 row_ror:4 row_mask:0xf bank_mask:0xf
  s_nop 0
  v_add_f32_dpp v22, v22, v22 row_ror:8 row_mask:0xf bank_mask:0xf
  v_add_f32_dpp v23, v23, v23 row_ror:8 row_mask:0xf bank_mask:0xf
  v_mov_b32 v24, v22
  v_mov_b32 v25, v23
  s_nop 0
  v_permlane16_swap_b32 v22, v24
  v_permlane16_swap_b32 v23, v25
  v_add_f32 v22, v22, v24
  v_add_f32 v23, v23, v25
  v_mov_b32 v24, v22
  v_mov_b32 v25, v23
  s_nop 0
  v_permlane32_swap_b32 v22, v24
  v_permlane32_swap_b32 v23, v25
  v_add_f32 v22, v22, v24
  v_add_f32 v23, v23, v25
  s_mov_b32 exec_lo, 0x1
  s_mov_b32 exec_hi, 0x0
  ds_write_b64 v19, v[22:23]
  s_mov_b64 exec, -1
  s_waitcnt lgkmcnt(0)
  s_barrier
  s_cmp_ge_u32 s96, 7
  s_cbranch_scc1 L_final
  ds_read_b64 v[22:23], v86
  s_waitcnt lgkmcnt(0)
  v_add_f32_dpp v22, v22, v22 quad_perm:[1,0,3,2] row_mask:0xf bank_mask:0xf
  v_add_f32_dpp v23, v23, v23 quad_perm:[1,0,3,2] row_mask:0xf bank_mask:0xf
  s_nop 0
  v_add_f32_dpp v22, v22, v22 quad_perm:[2,3,0,1] row_mask:0xf bank_mask:0xf
  v_add_f32_dpp v23, v23, v23 quad_perm:[2,3,0,1] row_mask:0xf bank_mask:0xf
  s_nop 0
  v_add_f32_dpp v22, v22, v22 row_half_mirror row_mask:0xf bank_mask:0xf
  v_add_f32_dpp v23, v23, v23 row_half_mirror row_mask:0xf bank_mask:0xf
  v_mul_f32 v22, 0x3b000000, v22
  v_mul_f32 v23, 0x3b000000, v23
  v_fma_f32 v23, -v22, v22, v23
  v_cvt_pk_bf16_f32 v24, v22, v23
  v_lshlrev_b32 v22, 16, v24
  v_and_b32 v23, 0xffff0000, v24
  v_add_f32 v23, 0x3727c5ac, v23
  v_cvt_pk_bf16_f32 v23, v23, v23
  v_lshlrev_b32 v23, 16, v23
  v_sqrt_f32 v23, v23
  v_sub_f32 v20, v20, v22
  v_cvt_pk_bf16_f32 v23, v23, v23
  v_lshlrev_b32 v23, 16, v23
  v_cvt_pk_bf16_f32 v20, v20, v20
  v_lshlrev_b32 v20, 16, v20
  v_rcp_f32 v24, v23
  s_nop 0
  v_mul_f32 v25, v20, v24
  v_fma_f32 v20, -v25, v23, v20
  v_fma_f32 v20, v20, v24, v25
  v_cvt_pk_bf16_f32 v20, v20, v20
  ds_write_b16 v17, v20
  ds_read_b128 v[44:47], v18
  s_waitcnt lgkmcnt(0)
  v_dot2_f32_bf16 v76, v44, v132, 0
  v_dot2_f32_bf16 v77, v44, v136, 0
  v_dot2_f32_bf16 v78, v44, v133, 0
  v_dot2_f32_bf16 v79, v44, v137, 0
  v_dot2_f32_bf16 v80, v44, v134, 0
  v_dot2_f32_bf16 v81, v44, v138, 0
  v_dot2_f32_bf16 v82, v44, v135, 0
  v_dot2_f32_bf16 v83, v44, v139, 0
  v_dot2_f32_bf16 v76, v45, v140, v76
  v_dot2_f32_bf16 v77, v45, v144, v77
  v_dot2_f32_bf16 v78, v45, v141, v78
  v_dot2_f32_bf16 v79, v45, v145, v79
  v_dot2_f32_bf16 v80, v45, v142, v80
  v_dot2_f32_bf16 v81, v45, v146, v81
  v_dot2_f32_bf16 v82, v45, v143, v82
  v_dot2_f32_bf16 v83, v45, v147, v83
  v_dot2_f32_bf16 v76, v46, v148, v76
  v_dot2_f32_bf16 v77, v46, v152, v77
  v_dot2_f32_bf16 v78, v46, v149, v78
  v_dot2_f32_bf16 v79, v46, v153, v79
  v_dot2_f32_bf16 v80, v46, v150, v80
  v_dot2_f32_bf16 v81, v46, v154, v81
  v_dot2_f32_bf16 v82, v46, v151, v82
  v_dot2_f32_bf16 v83, v46, v155, v83
  v_dot2_f32_bf16 v76, v47, v156, v76
  v_dot2_f32_bf16 v77, v47, v160, v77
  v_dot2_f32_bf16 v78, v47, v157, v78
  v_dot2_f32_bf16 v79, v47, v161, v79
  v_dot2_f32_bf16 v80, v47, v158, v80
  v_dot2_f32_bf16 v81, v47, v162, v81
  v_dot2_f32_bf16 v82, v47, v159, v82
  v_dot2_f32_bf16 v83, v47, v163, v83
  v_add_f32_dpp v76, v76, v76 row_half_mirror row_mask:0xf bank_mask:0x5
  v_add_f32_dpp v77, v77, v77 row_half_mirror row_mask:0xf bank_mask:0x5
  v_add_f32_dpp v78, v78, v78 row_half_mirror row_mask:0xf bank_mask:0x5
  v_add_f32_dpp v79, v79, v79 row_half_mirror row_mask:0xf bank_mask:0x5
  v_add_f32_dpp v76, v80, v80 row_half_mirror row_mask:0xf bank_mask:0xa
  v_add_f32_dpp v77, v81, v81 row_half_mirror row_mask:0xf bank_mask:0xa
  v_add_f32_dpp v78, v82, v82 row_half_mirror row_mask:0xf bank_mask:0xa
  v_add_f32_dpp v79, v83, v83 row_half_mirror row_mask:0xf bank_mask:0xa
  v_add_f32_dpp v76, v76, v76 quad_perm:[1,0,3,2] row_mask:0xf bank_mask:0xf
  v_add_f32_dpp v77, v77, v77 quad_perm:[1,0,3,2] row_mask:0xf bank_mask:0xf
  v_add_f32_dpp v78, v78, v78 quad_perm:[1,0,3,2] row_mask:0xf bank_mask:0xf
  v_add_f32_dpp v79, v79, v79 quad_perm:[1,0,3,2] row_mask:0xf bank_mask:0xf
  v_add_f32_dpp v76, v76, v76 quad_perm:[2,3,0,1] row_mask:0xf bank_mask:0xf
  v_add_f32_dpp v77, v77, v77 quad_perm:[2,3,0,1] row_mask:0xf bank_mask:0xf
  v_add_f32_dpp v78, v78, v78 quad_perm:[2,3,0,1] row_mask:0xf bank_mask:0xf
  v_add_f32_dpp v79, v79, v79 quad_perm:[2,3,0,1] row_mask:0xf bank_mask:0xf
  s_mov_b32 exec_lo, 0x11111111
  s_mov_b32 exec_hi, 0x11111111
  ds_write_b128 v87, v[76:79]
  s_mov_b64 exec, -1
  s_waitcnt lgkmcnt(0)
  s_barrier
  ds_read2st64_b32 v[44:45], v88 offset0:0 offset1:1
  ds_read2st64_b32 v[46:47], v88 offset0:2 offset1:3
  ds_read2st64_b32 v[48:49], v88 offset0:4 offset1:5
  ds_read2st64_b32 v[50:51], v88 offset0:6 offset1:7
  s_waitcnt lgkmcnt(0)
  v_add_f32 v44, v44, v45
  v_add_f32 v46, v46, v47
  v_add_f32 v48, v48, v49
  v_add_f32 v50, v50, v51
  v_add_f32 v44, v44, v46
  v_add_f32 v48, v48, v50
  v_add_f32 v44, v44, v48
  v_mov_b32 v45, v44
  s_nop 1
  v_permlane32_swap_b32 v44, v45
  v_cvt_pk_bf16_f32 v46, v44, v45
  v_lshlrev_b32 v44, 16, v46
  v_and_b32 v45, 0xffff0000, v46
  v_mul_f32 v46, v44, v44
  v_mov_b32 v47, 0x40135761
  v_fmac_f32 v47, 0x3dd2d3e8, v46
  v_mul_f32 v46, v44, v47
  v_exp_f32 v46, -v46
  s_nop 0
  v_add_f32 v46, 1.0, v46
  v_rcp_f32 v46, v46
  s_nop 0
  v_mul_f32 v44, v44, v46
  v_cvt_pk_bf16_f32 v44, v44, v44
  v_lshlrev_b32 v44, 16, v44
  v_mul_f32 v44, v44, v45
  v_cvt_pk_bf16_f32 v44, v44, v44
  s_nop 1
  v_mov_b32_dpp v45, v44 quad_perm:[1,0,3,2] row_mask:0xf bank_mask:0xf
  v_and_b32 v44, 0xffff, v44
  v_lshl_or_b32 v44, v45, 16, v44
  s_nop 0
  v_readlane_b32 s60, v44, 0
  v_readlane_b32 s61, v44, 2
  v_readlane_b32 s62, v44, 4
  v_readlane_b32 s63, v44, 6
  v_readlane_b32 s64, v44, 8
  v_readlane_b32 s65, v44, 10
  v_readlane_b32 s66, v44, 12
  v_readlane_b32 s67, v44, 14
  v_readlane_b32 s68, v44, 16
  v_readlane_b32 s69, v44, 18
  v_readlane_b32 s70, v44, 20
  v_readlane_b32 s71, v44, 22
  v_readlane_b32 s72, v44, 24
  v_readlane_b32 s73, v44, 26
  v_readlane_b32 s74, v44, 28
  v_readlane_b32 s75, v44, 30
  v_dot2_f32_bf16 v46, s60, v60, 0
  v_dot2_f32_bf16 v47, s61, v61, 0
  v_dot2_f32_bf16 v46, s62, v62, v46
  v_dot2_f32_bf16 v47, s63, v63, v47
  v_dot2_f32_bf16 v46, s64, v64, v46
  v_dot2_f32_bf16 v47, s65, v65, v47
  v_dot2_f32_bf16 v46, s66, v66, v46
  v_dot2_f32_bf16 v47, s67, v67, v47
  v_dot2_f32_bf16 v46, s68, v68, v46
  v_dot2_f32_bf16 v47, s69, v69, v47
  v_dot2_f32_bf16 v46, s70, v70, v46
  v_dot2_f32_bf16 v47, s71, v71, v47
  v_dot2_f32_bf16 v46, s72, v72, v46
  v_dot2_f32_bf16 v47, s73, v73, v47
  v_dot2_f32_bf16 v46, s74, v74, v46
  v_dot2_f32_bf16 v47, s75, v75, v47
  s_nop 2
  v_add_f32 v46, v46, v47
  v_min_u32 v46, -2, v46
  buffer_store_dword v46, v89, s[12:15], 0 offen sc1
  s_branch M_end
L_final:
  s_cmp_ge_u32 s3, 2
  s_cbranch_scc1 M_end
  ds_read_b32 v19, v91
  s_mov_b32 s61, 16384
  s_mov_b32 s62, 32768
  s_mov_b32 s63, 49152
  s_mov_b32 s64, 65536
  s_mov_b32 s65, 81920
  s_mov_b32 s66, 98304
  s_mov_b32 s85, 0
  buffer_load_dwordx4 v[52:55], v90, s[12:15], 0 offen sc1
  buffer_load_dwordx4 v[56:59], v90, s[12:15], s61 offen sc1
  buffer_load_dwordx4 v[60:63], v90, s[12:15], s62 offen sc1
  buffer_load_dwordx4 v[64:67], v90, s[12:15], s63 offen sc1
  buffer_load_dwordx4 v[68:71], v90, s[12:15], s64 offen sc1
  buffer_load_dwordx4 v[72:75], v90, s[12:15], s65 offen sc1
  buffer_load_dwordx4 v[76:79], v90, s[12:15], s66 offen sc1
  s_sleep 12
  buffer_load_dwordx4 v[132:135], v90, s[12:15], 0 offen sc1
  buffer_load_dwordx4 v[136:139], v90, s[12:15], s61 offen sc1
  buffer_load_dwordx4 v[140:143], v90, s[12:15], s62 offen sc1
  buffer_load_dwordx4 v[144:147], v90, s[12:15], s63 offen sc1
  buffer_load_dwordx4 v[148:151], v90, s[12:15], s64 offen sc1
  buffer_load_dwordx4 v[152:155], v90, s[12:15], s65 offen sc1
  buffer_load_dwordx4 v[156:159], v90, s[12:15], s66 offen sc1
dg_w_1435:
  s_waitcnt vmcnt(7)
  v_max3_u32 v48, v52, v53, v54
  v_max3_u32 v48, v48, v55, v56
  v_max3_u32 v48, v48, v57, v58
  v_max3_u32 v48, v48, v59, v60
  v_max3_u32 v48, v48, v61, v62
  v_max3_u32 v48, v48, v63, v64
  v_max3_u32 v48, v48, v65, v66
  v_max3_u32 v48, v48, v67, v68
  v_max3_u32 v48, v48, v69, v70
  v_max3_u32 v48, v48, v71, v72
  v_max3_u32 v48, v48, v73, v74
  v_max3_u32 v48, v48, v75, v76
  v_max3_u32 v48, v48, v77, v78
  v_max_u32 v48, v48, v79
  v_cmp_eq_u32 vcc, -1, v48
  s_cbranch_vccz dg_d_1437
  buffer_load_dwordx4 v[52:55], v90, s[12:15], 0 offen sc1
  buffer_load_dwordx4 v[56:59], v90, s[12:15], s61 offen sc1
  buffer_load_dwordx4 v[60:63], v90, s[12:15], s62 offen sc1
  buffer_load_dwordx4 v[64:67], v90, s[12:15], s63 offen sc1
  buffer_load_dwordx4 v[68:71], v90, s[12:15], s64 offen sc1
  buffer_load_dwordx4 v[72:75], v90, s[12:15], s65 offen sc1
  buffer_load_dwordx4 v[76:79], v90, s[12:15], s66 offen sc1
  s_waitcnt vmcnt(7)
  v_max3_u32 v48, v132, v133, v134
  v_max3_u32 v48, v48, v135, v136
  v_max3_u32 v48, v48, v137, v138
  v_max3_u32 v48, v48, v139, v140
  v_max3_u32 v48, v48, v141, v142
  v_max3_u32 v48, v48, v143, v144
  v_max3_u32 v48, v48, v145, v146
  v_max3_u32 v48, v48, v147, v148
  v_max3_u32 v48, v48, v149, v150
  v_max3_u32 v48, v48, v151, v152
  v_max3_u32 v48, v48, v153, v154
  v_max3_u32 v48, v48, v155, v156
  v_max3_u32 v48, v48, v157, v158
  v_max_u32 v48, v48, v159
  v_cmp_eq_u32 vcc, -1, v48
  s_cbranch_vccz dg_d_1438
  buffer_load_dwordx4 v[132:135], v90, s[12:15], 0 offen sc1
  buffer_load_dwordx4 v[136:139], v90, s[12:15], s61 offen sc1
  buffer_load_dwordx4 v[140:143], v90, s[12:15], s62 offen sc1
  buffer_load_dwordx4 v[144:147], v90, s[12:15], s63 offen sc1
  buffer_load_dwordx4 v[148:151], v90, s[12:15], s64 offen sc1
  buffer_load_dwordx4 v[152:155], v90, s[12:15], s65 offen sc1
  buffer_load_dwordx4 v[156:159], v90, s[12:15], s66 offen sc1
  s_add_u32 s85, s85, 1
  s_cmp_gt_u32 s85, 200000
  s_cbranch_scc1 M_end
  s_branch dg_w_1435
dg_d_1437:
  v_pk_add_f32 v[20:21], v[52:53], v[56:57]
  v_pk_add_f32 v[28:29], v[60:61], v[64:65]
  v_pk_add_f32 v[36:37], v[68:69], v[72:73]
  v_pk_add_f32 v[22:23], v[54:55], v[58:59]
  v_pk_add_f32 v[30:31], v[62:63], v[66:67]
  v_pk_add_f32 v[38:39], v[70:71], v[74:75]
  v_pk_add_f32 v[20:21], v[20:21], v[28:29]
  v_pk_add_f32 v[36:37], v[36:37], v[76:77]
  v_pk_add_f32 v[22:23], v[22:23], v[30:31]
  v_pk_add_f32 v[38:39], v[38:39], v[78:79]
  s_branch dg_j_1436
dg_d_1438:
  v_pk_add_f32 v[20:21], v[132:133], v[136:137]
  v_pk_add_f32 v[28:29], v[140:141], v[144:145]
  v_pk_add_f32 v[36:37], v[148:149], v[152:153]
  v_pk_add_f32 v[22:23], v[134:135], v[138:139]
  v_pk_add_f32 v[30:31], v[142:143], v[146:147]
  v_pk_add_f32 v[38:39], v[150:151], v[154:155]
  v_pk_add_f32 v[20:21], v[20:21], v[28:29]
  v_pk_add_f32 v[36:37], v[36:37], v[156:157]
  v_pk_add_f32 v[22:23], v[22:23], v[30:31]
  v_pk_add_f32 v[38:39], v[38:39], v[158:159]
dg_j_1436:
  v_pk_add_f32 v[20:21], v[20:21], v[36:37]
  v_pk_add_f32 v[22:23], v[22:23], v[38:39]
  s_nop 1
  v_permlane32_swap_b32 v20, v22
  v_permlane32_swap_b32 v21, v23
  v_pk_add_f32 v[20:21], v[20:21], v[22:23]
  s_nop 1
  v_permlane16_swap_b32 v20, v21
  v_add_f32 v20, v20, v21
  s_nop 1
  v_add_f32_dpp v20, v20, v20 row_ror:8 row_mask:0xf bank_mask:0xf
  v_cvt_pk_bf16_f32 v20, v20, v20
  v_lshlrev_b32 v20, 16, v20
  s_waitcnt lgkmcnt(0)
  v_add_f32 v20, v20, v19
  v_cvt_pk_bf16_f32 v20, v20, v20
  s_mov_b32 exec_lo, 0xff00ff
  s_mov_b32 exec_hi, 0xff00ff
  buffer_store_short v20, v92, s[48:51], 0 offen
  s_mov_b64 exec, -1
M_end:
  s_endpgm
K_helper:
  s_setprio 3
  v_lshlrev_b32 v4, 4, v2
  v_mov_b32 v16, s80
  v_and_b32 v6, 1, v2
  v_lshlrev_b32 v6, 2, v6
  v_and_b32 v7, 2, v2
  v_lshl_add_u32 v7, v7, 6, v6
  v_mov_b32 v13, 1
  v_mov_b32 v8, -1
  v_mov_b32 v9, -1
  v_mov_b32 v10, -1
  v_mov_b32 v11, -1
  s_cmp_ge_u32 s81, 24
  s_cbranch_scc1 H_svc
  s_lshl_b32 s86, s80, 13
  s_lshl_b32 s87, s81, 8
  s_add_u32 s87, s86, s87
  v_lshlrev_b32 v3, 2, v2
  v_add_u32 v14, s87, v3
  v_add_u32 v15, s86, v4
  s_movk_i32 s84, 0x1000
  s_mul_i32 s88, s80, 24
  s_add_u32 s88, s88, s81
  s_lshl_b32 s86, s88, 10
  s_add_u32 s86, s86, 1048576
  v_add_u32 v5, s86, v4
  s_lshl_b32 s86, s88, 5
  s_add_u32 s86, s86, 65536
  v_add_u32 v18, s86, v4
  s_waitcnt lgkmcnt(0)
  s_mov_b32 s12, s78
  s_and_b32 s13, s79, 0xffff
  s_mov_b32 s14, 0x400000
  s_mov_b32 s15, 0x20000
  s_mov_b32 s52, s76
  s_and_b32 s53, s77, 0xffff
  s_mov_b32 s54, 0x100
  s_mov_b32 s55, 0x20000
  buffer_load_dword v12, v14, s[12:15], 0 offen sc1
  buffer_load_dwordx4 v[20:23], v15, s[12:15], 0 offen offset:0 sc1
  buffer_load_dwordx4 v[24:27], v15, s[12:15], 0 offen offset:1024 sc1
  buffer_load_dwordx4 v[28:31], v15, s[12:15], 0 offen offset:2048 sc1
  buffer_load_dwordx4 v[32:35], v15, s[12:15], 0 offen offset:3072 sc1
  buffer_load_dwordx4 v[36:39], v15, s[12:15], s84 offen offset:0 sc1
  buffer_load_dwordx4 v[40:43], v15, s[12:15], s84 offen offset:1024 sc1
  s_barrier
  buffer_store_dwordx4 v[8:11], v5, s[12:15], 0 offen sc1
  s_mov_b32 exec_lo, 0x3
  s_mov_b32 exec_hi, 0x0
  buffer_store_dwordx4 v[8:11], v18, s[12:15], 0 offen sc1
  s_mov_b64 exec, -1
  s_lshl_b32 s86, s80, 10
  s_add_u32 s86, s86, 196608
  s_cmp_eq_u32 s81, 0
  s_cselect_b32 s86, s86, 0x7ffefff0
  v_lshlrev_b32 v19, 8, v2
  v_add_u32 v19, s86, v19
  v_mov_b32 v17, 0
  s_mov_b32 exec_lo, 0xf
  s_mov_b32 exec_hi, 0x0
  buffer_store_dword v17, v19, s[12:15], 0 offen sc1
  s_mov_b64 exec, -1
  v_lshlrev_b32 v19, 2, v2
  v_add_u32 v19, 131072, v19
  v_lshlrev_b32 v17, 3, v2
  v_add_u32 v17, 133120, v17
  s_waitcnt vmcnt(3)
  v_not_b32 v12, v12
  v_and_b32 v12, 1, v12
  s_barrier
  ds_read2st64_b32 v[84:85], v19 offset0:0 offset1:1
  ds_read2st64_b32 v[86:87], v19 offset0:2 offset1:3
  ds_read2st64_b32 v[88:89], v19 offset0:4 offset1:5
  ds_read2st64_b32 v[90:91], v19 offset0:6 offset1:7
  s_waitcnt lgkmcnt(0)
  v_add_f32 v84, v84, v85
  v_add_f32 v86, v86, v87
  v_add_f32 v88, v88, v89
  v_add_f32 v90, v90, v91
  v_add_f32 v84, v84, v86
  v_add_f32 v88, v88, v90
  v_add_f32 v84, v84, v88
  v_and_or_b32 v84, v84, -2, v12
  s_waitcnt vmcnt(0)
  buffer_store_dword v84, v14, s[12:15], 0 offen sc1
  s_mov_b32 s85, 0
  s_mov_b32 s89, 0
  v_mov_b32 v8, 0
  buffer_load_dwordx4 v[52:55], v15, s[12:15], 0 offen offset:0 sc1
  buffer_load_dwordx4 v[56:59], v15, s[12:15], 0 offen offset:1024 sc1
  buffer_load_dwordx4 v[60:63], v15, s[12:15], 0 offen offset:2048 sc1
  buffer_load_dwordx4 v[64:67], v15, s[12:15], 0 offen offset:3072 sc1
  buffer_load_dwordx4 v[68:71], v15, s[12:15], s84 offen offset:0 sc1
  buffer_load_dwordx4 v[72:75], v15, s[12:15], s84 offen offset:1024 sc1
  s_barrier
hq_1439:
  s_waitcnt vmcnt(0)
  v_xor_b32 v9, v20, v52
  v_bitop3_b32 v9, v9, v21, v53 bitop3:0x60
  v_bitop3_b32 v9, v9, v22, v54 bitop3:0x60
  v_bitop3_b32 v9, v9, v23, v55 bitop3:0x60
  v_bitop3_b32 v9, v9, v24, v56 bitop3:0x60
  v_bitop3_b32 v9, v9, v25, v57 bitop3:0x60
  v_bitop3_b32 v9, v9, v26, v58 bitop3:0x60
  v_bitop3_b32 v9, v9, v27, v59 bitop3:0x60
  v_bitop3_b32 v9, v9, v28, v60 bitop3:0x60
  v_bitop3_b32 v9, v9, v29, v61 bitop3:0x60
  v_bitop3_b32 v9, v9, v30, v62 bitop3:0x60
  v_bitop3_b32 v9, v9, v31, v63 bitop3:0x60
  v_bitop3_b32 v9, v9, v32, v64 bitop3:0x60
  v_bitop3_b32 v9, v9, v33, v65 bitop3:0x60
  v_bitop3_b32 v9, v9, v34, v66 bitop3:0x60
  v_bitop3_b32 v9, v9, v35, v67 bitop3:0x60
  v_bitop3_b32 v9, v9, v36, v68 bitop3:0x60
  v_bitop3_b32 v9, v9, v37, v69 bitop3:0x60
  v_bitop3_b32 v9, v9, v38, v70 bitop3:0x60
  v_bitop3_b32 v9, v9, v39, v71 bitop3:0x60
  v_bitop3_b32 v9, v9, v40, v72 bitop3:0x60
  v_bitop3_b32 v9, v9, v41, v73 bitop3:0x60
  v_bitop3_b32 v9, v9, v42, v74 bitop3:0x60
  v_bitop3_b32 v9, v9, v43, v75 bitop3:0x60
  v_and_b32 v9, 1, v9
  v_cmp_eq_u32 vcc, 0, v9
  s_cbranch_vccz hq_done
  s_cmp_lg_u32 s89, 0
  s_cbranch_scc1 hq_done
  v_cmp_ne_u32 vcc, 1, v8
  s_cmp_eq_u64 vcc, 0
  s_cselect_b32 s89, 1, 0
  s_add_u32 s85, s85, 1
  s_cmp_gt_u32 s85, 200000
  s_cbranch_scc1 H_end
  s_cmp_lt_u32 s85, 3
  s_cbranch_scc1 hnf_1440
  buffer_load_ubyte v8, v16, s[52:55], 0 offen sc1
hnf_1440:
  buffer_load_dwordx4 v[52:55], v15, s[12:15], 0 offen offset:0 sc1
  buffer_load_dwordx4 v[56:59], v15, s[12:15], 0 offen offset:1024 sc1
  buffer_load_dwordx4 v[60:63], v15, s[12:15], 0 offen offset:2048 sc1
  buffer_load_dwordx4 v[64:67], v15, s[12:15], 0 offen offset:3072 sc1
  buffer_load_dwordx4 v[68:71], v15, s[12:15], s84 offen offset:0 sc1
  buffer_load_dwordx4 v[72:75], v15, s[12:15], s84 offen offset:1024 sc1
  s_branch hq_1439
hq_done:
  v_and_b32 v52, -2, v52
  v_and_b32 v53, -2, v53
  v_and_b32 v54, -2, v54
  v_and_b32 v55, -2, v55
  v_and_b32 v56, -2, v56
  v_and_b32 v57, -2, v57
  v_and_b32 v58, -2, v58
  v_and_b32 v59, -2, v59
  v_and_b32 v60, -2, v60
  v_and_b32 v61, -2, v61
  v_and_b32 v62, -2, v62
  v_and_b32 v63, -2, v63
  v_and_b32 v64, -2, v64
  v_and_b32 v65, -2, v65
  v_and_b32 v66, -2, v66
  v_and_b32 v67, -2, v67
  v_and_b32 v68, -2, v68
  v_and_b32 v69, -2, v69
  v_and_b32 v70, -2, v70
  v_and_b32 v71, -2, v71
  v_and_b32 v72, -2, v72
  v_and_b32 v73, -2, v73
  v_and_b32 v74, -2, v74
  v_and_b32 v75, -2, v75
  v_add_f32 v52, v52, v60
  v_add_f32 v53, v53, v61
  v_add_f32 v54, v54, v62
  v_add_f32 v55, v55, v63
  v_add_f32 v52, v52, v68
  v_add_f32 v53, v53, v69
  v_add_f32 v54, v54, v70
  v_add_f32 v55, v55, v71
  v_cvt_pk_bf16_f32 v84, v52, v53
  v_cvt_pk_bf16_f32 v85, v54, v55
  v_add_f32 v56, v56, v64
  v_add_f32 v57, v57, v65
  v_add_f32 v58, v58, v66
  v_add_f32 v59, v59, v67
  v_add_f32 v56, v56, v72
  v_add_f32 v57, v57, v73
  v_add_f32 v58, v58, v74
  v_add_f32 v59, v59, v75
  v_cvt_pk_bf16_f32 v86, v56, v57
  v_cvt_pk_bf16_f32 v87, v58, v59
  ds_write_b64 v17, v[84:85]
  ds_write_b64 v17, v[86:87] offset:512
  s_waitcnt lgkmcnt(0)
  s_barrier
  s_cmp_lg_u32 s89, 0
  s_cbranch_scc1 H_ml
  s_cmp_eq_u32 s81, 0
  s_cbranch_scc1 gst_1442
  s_mov_b32 s86, s81
gwait_1443:
  s_sleep 32
  s_sub_u32 s86, s86, 1
  s_cmp_lg_u32 s86, 0
  s_cbranch_scc1 gwait_1443
  buffer_load_ubyte v8, v16, s[52:55], 0 offen sc1
  s_waitcnt vmcnt(0)
  v_cmp_ne_u32 vcc, 1, v8
  s_cbranch_vccz H_ml
gst_1442:
  s_mov_b32 exec_lo, 0x1
  s_mov_b32 exec_hi, 0x0
  buffer_store_byte v13, v16, s[52:55], 0 offen sc1
  s_mov_b64 exec, -1
H_ml:
  v_and_b32 v3, 3, v2
  v_bfe_u32 v5, v2, 2, 3
  v_mul_u32_u24 v5, 16416, v5
  v_lshl_add_u32 v5, v3, 3, v5
  v_add_u32 v5, 2048, v5
  s_mul_i32 s88, s80, 24
  s_add_u32 s88, s88, s81
  s_lshl_b32 s86, s88, 5
  s_add_u32 s86, s86, 65536
  v_lshl_add_u32 v6, v3, 3, s86
  s_cmp_ge_u32 s81, 7
  s_cbranch_scc1 nosf_1444
  v_and_b32 v7, 1, v2
  v_lshlrev_b32 v7, 2, v7
  v_add_u32 v7, 128, v7
  s_mov_b32 s16, s56
  s_and_b32 s17, s57, 0xffff
  s_mov_b32 s18, 0x400
  s_mov_b32 s19, 0x20000
  buffer_load_dwordx4 v[24:27], v4, s[16:19], 0 offen
  s_mov_b32 s85, 0
  buffer_load_dword v8, v7, s[52:55], 0 offen sc1
hs_w_1445:
  s_waitcnt vmcnt(0)
  v_and_b32 v8, 0x01010101, v8
  v_cmp_ne_u32 vcc, 0x01010101, v8
  s_cbranch_vccz hs_d_1446
  s_add_u32 s85, s85, 1
  s_cmp_gt_u32 s85, 200000
  s_cbranch_scc1 H_end
  s_sleep 100
  buffer_load_dword v8, v7, s[52:55], 0 offen sc1
  s_branch hs_w_1445
hs_d_1446:
  v_add_u32 v7, 132096, v4
  ds_write_b128 v7, v[24:27]
  s_waitcnt lgkmcnt(0)
nosf_1444:
  s_barrier
  ds_read_b64 v[20:21], v5
  s_waitcnt lgkmcnt(0)
  v_mov_b32 v22, v20
  s_nop 1
  v_max_f32_dpp v22, v22, v22 row_ror:4 row_mask:0xf bank_mask:0xf
  s_nop 1
  v_max_f32_dpp v22, v22, v22 row_ror:8 row_mask:0xf bank_mask:0xf
  v_mov_b32 v24, v22
  s_nop 1
  v_permlane16_swap_b32 v22, v24
  v_max_f32 v22, v22, v24
  v_sub_f32 v20, v20, v22
  v_exp_f32 v20, v20
  s_nop 0
  v_mul_f32 v23, v20, v21
  s_nop 1
  v_add_f32_dpp v23, v23, v23 row_ror:4 row_mask:0xf bank_mask:0xf
  s_nop 1
  v_add_f32_dpp v23, v23, v23 row_ror:8 row_mask:0xf bank_mask:0xf
  v_mov_b32 v24, v23
  s_nop 1
  v_permlane16_swap_b32 v23, v24
  v_add_f32 v23, v23, v24
  s_mov_b32 exec_lo, 0xf
  s_mov_b32 exec_hi, 0x0
  buffer_store_dwordx2 v[22:23], v6, s[12:15], 0 offen sc1
  s_mov_b64 exec, -1
  s_cmp_ge_u32 s81, 7
  s_cbranch_scc1 H_end
  s_barrier
  s_branch H_end
H_svc:
  s_sub_u32 s89, s81, 24
  s_lshl_b32 s86, s80, 11
  s_lshl_b32 s87, s89, 8
  s_add_u32 s86, s86, s87
  s_add_u32 s86, s86, 131072
  v_add_u32 v18, s86, v4
  s_mul_i32 s86, s80, 7
  s_add_u32 s86, s86, s89
  s_lshl_b32 s86, s86, 11
  s_add_u32 s86, s86, 262144
  s_cmp_lt_u32 s89, 7
  s_cselect_b32 s86, s86, 0x7fffeff0
  v_add_u32 v5, s86, v4
  s_mul_i32 s86, s80, 768
  s_add_u32 s86, s86, 65536
  v_add_u32 v17, s86, v4
  s_waitcnt lgkmcnt(0)
  s_mov_b32 s12, s78
  s_and_b32 s13, s79, 0xffff
  s_mov_b32 s14, 0x400000
  s_mov_b32 s15, 0x20000
  s_mov_b32 s52, s76
  s_and_b32 s53, s77, 0xffff
  s_mov_b32 s54, 0x100
  s_mov_b32 s55, 0x20000
  s_cmp_lg_u32 s89, 0
  s_cbranch_scc1 noclr_1447
  s_lshl_b32 s86, s80, 11
  s_add_u32 s86, s86, 131072
  v_add_u32 v18, s86, v4
  s_mul_i32 s86, s80, 14336
  s_add_u32 s86, s86, 262144
  v_add_u32 v5, s86, v4
  buffer_store_dwordx4 v[8:11], v18, s[12:15], 0 offen offset:0 sc1
  buffer_store_dwordx4 v[8:11], v18, s[12:15], 0 offen offset:1024 sc1
  buffer_store_dwordx4 v[8:11], v5, s[12:15], 0 offen offset:0 sc1
  buffer_store_dwordx4 v[8:11], v5, s[12:15], 0 offen offset:1024 sc1
  buffer_store_dwordx4 v[8:11], v5, s[12:15], 0 offen offset:2048 sc1
  buffer_store_dwordx4 v[8:11], v5, s[12:15], 0 offen offset:3072 sc1
  v_add_u32 v5, 0x1000, v5
  buffer_store_dwordx4 v[8:11], v5, s[12:15], 0 offen offset:0 sc1
  buffer_store_dwordx4 v[8:11], v5, s[12:15], 0 offen offset:1024 sc1
  buffer_store_dwordx4 v[8:11], v5, s[12:15], 0 offen offset:2048 sc1
  buffer_store_dwordx4 v[8:11], v5, s[12:15], 0 offen offset:3072 sc1
  v_add_u32 v5, 0x1000, v5
  buffer_store_dwordx4 v[8:11], v5, s[12:15], 0 offen offset:0 sc1
  buffer_store_dwordx4 v[8:11], v5, s[12:15], 0 offen offset:1024 sc1
  buffer_store_dwordx4 v[8:11], v5, s[12:15], 0 offen offset:2048 sc1
  buffer_store_dwordx4 v[8:11], v5, s[12:15], 0 offen offset:3072 sc1
  v_add_u32 v5, 0x1000, v5
  buffer_store_dwordx4 v[8:11], v5, s[12:15], 0 offen offset:0 sc1
  buffer_store_dwordx4 v[8:11], v5, s[12:15], 0 offen offset:1024 sc1
  v_add_u32 v16, 128, v16
  s_waitcnt vmcnt(0)
  s_mov_b32 exec_lo, 0x1
  s_mov_b32 exec_hi, 0x0
  buffer_store_byte v13, v16, s[52:55], 0 offen sc1
  s_mov_b64 exec, -1
noclr_1447:
  s_mov_b32 s85, 0
  buffer_load_dword v8, v7, s[52:55], 0 offen sc1
ha_w_1448:
  s_waitcnt vmcnt(0)
  v_and_b32 v8, 0x01010101, v8
  v_cmp_ne_u32 vcc, 0x01010101, v8
  s_cbranch_vccz ha_d_1449
  s_add_u32 s85, s85, 1
  s_cmp_gt_u32 s85, 200000
  s_cbranch_scc1 H_end
  s_sleep 100
  buffer_load_dword v8, v7, s[52:55], 0 offen sc1
  s_branch ha_w_1448
ha_d_1449:
  v_mov_b32 v20, 0xff800000
  v_mov_b32 v21, 0
  v_mov_b32 v22, 0xff800000
  v_mov_b32 v23, 0
  v_and_b32 v5, 1, v2
  v_lshlrev_b32 v5, 8, v5
  v_bfe_u32 v6, v2, 1, 3
  v_lshl_add_u32 v5, v6, 4, v5
  v_lshrrev_b32 v6, 4, v2
  v_lshl_add_u32 v5, v6, 2, v5
  v_add_u32 v5, 8192, v5
  s_mov_b32 exec_lo, 0xffffffff
  s_mov_b32 exec_hi, 0xffff
  s_mov_b32 s85, 0
  s_mov_b32 s87, 0
  buffer_load_dwordx4 v[20:23], v17, s[12:15], 0 offen sc1
hm_w_1450:
  s_waitcnt vmcnt(0)
  v_max3_u32 v24, v20, v21, v22
  v_max_u32 v24, v24, v23
  v_cmp_ne_u32 vcc, -1, v24
  s_bcnt1_i32_b64 s86, vcc
  s_cmp_lg_u32 s87, 0
  s_cbranch_scc1 hm_1_1451
  s_cmp_lt_u32 s86, 24
  s_cbranch_scc1 hm_2_1452
  s_barrier
  s_mov_b32 s87, 1
hm_1_1451:
  s_cmp_eq_u32 s86, 48
  s_cbranch_scc1 hm_d_1454
  s_sleep 1
  s_branch hm_3_1453
hm_2_1452:
  s_sleep 8
hm_3_1453:
  s_add_u32 s85, s85, 1
  s_cmp_gt_u32 s85, 200000
  s_cbranch_scc1 H_end
  buffer_load_dwordx4 v[20:23], v17, s[12:15], 0 offen sc1
  s_branch hm_w_1450
hm_d_1454:
  s_mov_b64 exec, -1
  v_mov_b32 v25, v20
  v_mov_b32 v26, v22
  s_nop 0
  v_max_f32_dpp v25, v25, v25 quad_perm:[2,3,0,1] row_mask:0xf bank_mask:0xf
  v_max_f32_dpp v26, v26, v26 quad_perm:[2,3,0,1] row_mask:0xf bank_mask:0xf
  s_nop 0
  v_max_f32_dpp v25, v25, v25 row_ror:4 row_mask:0xf bank_mask:0xf
  v_max_f32_dpp v26, v26, v26 row_ror:4 row_mask:0xf bank_mask:0xf
  s_nop 0
  v_max_f32_dpp v25, v25, v25 row_ror:8 row_mask:0xf bank_mask:0xf
  v_max_f32_dpp v26, v26, v26 row_ror:8 row_mask:0xf bank_mask:0xf
  v_mov_b32 v27, v25
  v_mov_b32 v28, v26
  s_nop 0
  v_permlane16_swap_b32 v25, v27
  v_permlane16_swap_b32 v26, v28
  v_max_f32 v25, v25, v27
  v_max_f32 v26, v26, v28
  v_mov_b32 v27, v25
  v_mov_b32 v28, v26
  s_nop 0
  v_permlane32_swap_b32 v25, v27
  v_permlane32_swap_b32 v26, v28
  v_max_f32 v25, v25, v27
  v_max_f32 v26, v26, v28
  v_sub_f32 v20, v20, v25
  v_sub_f32 v22, v22, v26
  v_exp_f32 v20, v20
  v_exp_f32 v22, v22
  s_nop 0
  v_cvt_pk_bf16_f32 v27, v20, v22
  v_lshlrev_b32 v20, 16, v27
  v_and_b32 v22, 0xffff0000, v27
  v_mul_f32 v21, v20, v21
  v_mul_f32 v23, v22, v23
  s_nop 0
  v_add_f32_dpp v21, v21, v21 quad_perm:[2,3,0,1] row_mask:0xf bank_mask:0xf
  v_add_f32_dpp v23, v23, v23 quad_perm:[2,3,0,1] row_mask:0xf bank_mask:0xf
  s_nop 0
  v_add_f32_dpp v21, v21, v21 row_ror:4 row_mask:0xf bank_mask:0xf
  v_add_f32_dpp v23, v23, v23 row_ror:4 row_mask:0xf bank_mask:0xf
  s_nop 0
  v_add_f32_dpp v21, v21, v21 row_ror:8 row_mask:0xf bank_mask:0xf
  v_add_f32_dpp v23, v23, v23 row_ror:8 row_mask:0xf bank_mask:0xf
  v_mov_b32 v27, v21
  v_mov_b32 v28, v23
  s_nop 0
  v_permlane16_swap_b32 v21, v27
  v_permlane16_swap_b32 v23, v28
  v_add_f32 v21, v21, v27
  v_add_f32 v23, v23, v28
  v_mov_b32 v27, v21
  v_mov_b32 v28, v23
  s_nop 0
  v_permlane32_swap_b32 v21, v27
  v_permlane32_swap_b32 v23, v28
  v_add_f32 v21, v21, v27
  v_add_f32 v23, v23, v28
  v_rcp_f32 v21, v21
  v_rcp_f32 v23, v23
  v_cmp_lt_u32 vcc, 47, v2
  s_nop 1
  v_cndmask_b32 v20, v20, v21, vcc
  v_cndmask_b32 v22, v22, v23, vcc
  ds_write_b32 v5, v20
  ds_write_b32 v5, v22 offset:128
  s_waitcnt lgkmcnt(0)
  s_barrier
H_end:
  s_endpgm
K_exit:
  s_endpgm
.section .rodata,"a"
.p2align 6
.amdhsa_kernel sequential_preLN__gqa_block_cached__geglu_ffn__decode_kernel
  .amdhsa_next_free_vgpr 168
  .amdhsa_next_free_sgpr 102
  .amdhsa_accum_offset 168
  .amdhsa_group_segment_fixed_size 0
  .amdhsa_kernarg_size 96
  .amdhsa_user_sgpr_count 2
  .amdhsa_user_sgpr_kernarg_segment_ptr 1
  .amdhsa_system_sgpr_workgroup_id_x 1
.end_amdhsa_kernel
```
